```python
import torch

def _softmax(x, axis=-1):
    return torch.softmax(x, dim=axis)

def _gelu(x):
    return torch.nn.functional.gelu(x, approximate='tanh')

def _silu(x):
    return torch.nn.functional.silu(x)

def _sigmoid(x):
    return torch.sigmoid(x)

def _layernorm(x, axis=-1, eps=1e-05):
    m = x.mean(dim=axis, keepdim=True)
    v = x.var(dim=axis, keepdim=True, unbiased=False)
    return (x - m) / torch.sqrt(v + eps)

def _scatter_add(tgt, idx, src, axis=0):
    return tgt.clone().index_add_(axis, idx, src)

def _segment_sum(src, seg, n):
    out = torch.zeros((n,) + src.shape[1:], dtype=src.dtype)
    return out.index_add_(0, seg, src)

def _pad(x, pw):
    flat = tuple((v for pair in reversed(pw) for v in pair))
    return torch.nn.functional.pad(x, flat)
kernel_name = 'adaLN_cond__sliding_block_cached__mixer_channel_mlp__decode'

def setup_inputs():

    _w = lambda a: (lambda t: t.to(torch.bfloat16) if t.is_floating_point() else t)(torch.as_tensor(a))

    def _A_setup():
        B, Sq, D = (2, 1, 576)
        Hq, Hkv, Sk, Dh = (32, 16, 8192, 128)
        assert Hq % Hkv == 0, (Hq, Hkv)
        return {'x': _w((lambda *s: torch.randn(*s, dtype=torch.bfloat16) * 0.1)(B, Sq, D)), 'k_cache': _w((lambda *s: torch.randn(*s, dtype=torch.bfloat16) * 0.8)(B, Hkv, Sk, Dh)), 'v_cache': _w((lambda *s: torch.randn(*s, dtype=torch.bfloat16) * 0.8)(B, Hkv, Sk, Dh)), 'wq': _w((lambda *s: torch.randn(*s, dtype=torch.bfloat16) * 0.8)(D, Hq * Dh) * D ** (-0.5)), 'wo': _w((lambda *s: torch.randn(*s, dtype=torch.bfloat16) * 0.8)(Hq * Dh, D) * (Hq * Dh) ** (-0.5))}
    _A_in = _A_setup()

    def _B_setup():
        B, S, D, F = (2, 1, 576, 4608)
        return {'x': _w((lambda *s: torch.randn(*s, dtype=torch.bfloat16) * 0.1)(B, S, D)), 'w1': _w((lambda *s: torch.randn(*s, dtype=torch.bfloat16) * 3.2)(D, F) * D ** (-0.5)), 'b1': _w((lambda *s: torch.randn(*s, dtype=torch.bfloat16) * 3.2)(F)), 'w2': _w((lambda *s: torch.randn(*s, dtype=torch.bfloat16) * 3.2)(F, D) * F ** (-0.5)), 'b2': _w((lambda *s: torch.randn(*s, dtype=torch.bfloat16) * 3.2)(D))}
    _B_in = _B_setup()
    return {'A_x': _A_in['x'], 'A_k_cache': _A_in['k_cache'], 'A_v_cache': _A_in['v_cache'], 'A_wq': _A_in['wq'], 'A_wo': _A_in['wo'], 'B_x': _B_in['x'], 'B_w1': _B_in['w1'], 'B_b1': _B_in['b1'], 'B_w2': _B_in['w2'], 'B_b2': _B_in['b2'], 'c': _w((lambda *s: torch.randn(*s, dtype=torch.bfloat16) * 0.4)(2, 576) * 8.0), 'w_mod': _w((lambda *s: torch.randn(*s, dtype=torch.bfloat16) * 0.4)(576, 6 * 576) * 576 ** (-0.5) * 8.0)}

def reference(A_x, A_k_cache, A_v_cache, A_wq, A_wo, B_x, B_w1, B_b1, B_w2, B_b2, c, w_mod):

    def _A_ref(x, k_cache, v_cache, wq, wo):
        B, Sq, D = x.shape
        Hq, Dh = (32, 128)
        Hkv, Sk = (k_cache.shape[1], k_cache.shape[2])
        W = min(4096, max(256, Sk // 4))
        rep = Hq // Hkv
        q = (lambda x, *d: x.permute(*d))((x @ wq).reshape(B, Sq, Hq, Dh), 0, 2, 1, 3)
        k = (lambda x, n, axis: torch.repeat_interleave(x, n, dim=axis))(k_cache[:, :, Sk - W:, :], rep, axis=1)
        v = (lambda x, n, axis: torch.repeat_interleave(x, n, dim=axis))(v_cache[:, :, Sk - W:, :], rep, axis=1)
        scores = torch.einsum('bhqd,bhkd->bhqk', q, k) * Dh ** (-0.5)
        p = _softmax(scores, axis=-1)
        o = torch.einsum('bhqk,bhkd->bhqd', p, v)
        return (lambda x, *d: x.permute(*d))(o, 0, 2, 1, 3).reshape(B, Sq, Hq * Dh) @ wo

    def _B_ref(x, w1, b1, w2, b2):
        y = _layernorm(x, axis=-1)
        h = _gelu(torch.einsum('bsd,df->bsf', y, w1) + b1)
        return torch.einsum('bsf,fd->bsd', h, w2) + b2
    x = A_x
    mod = (_silu(c) @ w_mod).reshape(c.shape[0], 6, 1, -1)
    sa, ca, ga, sb, cb, gb = (mod[:, 0].clone(), mod[:, 1].clone(), mod[:, 2].clone(), mod[:, 3].clone(), mod[:, 4].clone(), mod[:, 5].clone())
    h = _layernorm(x, axis=-1) * (1 + ca) + sa
    x = x + ga * _A_ref(h, A_k_cache, A_v_cache, A_wq, A_wo)
    h = _layernorm(x, axis=-1) * (1 + cb) + sb
    x = x + gb * _B_ref(h, B_w1, B_b1, B_w2, B_b2)
    return x
```

```asm
; @launch grid=(256,1,1) block=(1024,1,1) lds=158208
.amdgcn_target "amdgcn-amd-amdhsa--gfx950"
.text
.globl adaLN_cond__sliding_block_cached__mixer_channel_mlp__decode_kernel
.p2align 8
.type adaLN_cond__sliding_block_cached__mixer_channel_mlp__decode_kernel,@function
adaLN_cond__sliding_block_cached__mixer_channel_mlp__decode_kernel:
    s_cmp_ge_u32 s2, 256
    s_cbranch_scc1 L_exit
    s_load_dwordx16 s[16:31], s[0:1], 0
    s_load_dwordx8 s[32:39], s[0:1], 64
    s_load_dwordx4 s[40:43], s[0:1], 96
    s_load_dwordx2 s[44:45], s[0:1], 112
    s_getpc_b64 s[46:47]
L_pc:
    s_lshr_b32 s5, s2, 3
    s_mulk_i32 s5, 640
    v_lshl_add_u32 v4, v0, 7, s5
    v_min_u32 v4, L_exit-L_pc, v4
    v_cmp_gt_u32 vcc, 5, v0
    s_nop 0
    s_and_saveexec_b64 s[50:51], vcc
    s_cbranch_execz L_nocpf
    global_load_dword v124, v4, s[46:47]
L_nocpf:
    s_mov_b64 exec, s[50:51]
    v_lshrrev_b32 v4, 6, v0
    v_and_b32 v1, 63, v0
    v_readfirstlane_b32 s3, v4
    v_and_b32 v2, 15, v0
    v_bfe_u32 v3, v0, 4, 2
    v_mov_b32 v5, 0
    v_mov_b32 v8, 0x2000
    v_mov_b32 v9, 0x2000
    s_and_b32 s4, s2, 7
    s_lshr_b32 s5, s2, 3
    s_sub_u32 s8, s3, 7
    s_mov_b32 s54, 0xffff0000
    s_mov_b32 s13, 1048576
    s_cmp_ge_u32 s5, 28
    s_cbranch_scc1 L_role_x
    s_cmp_ge_u32 s5, 20
    s_cbranch_scc1 L_role_q
    s_cmp_ge_u32 s3, 2
    s_cbranch_scc1 L_role_att
    v_lshrrev_b32 v4, 3, v1
    v_lshlrev_b32 v4, 13, v4
    v_and_b32 v5, 7, v1
    v_lshl_add_u32 v4, v5, 7, v4
    s_lshl_b32 s14, s5, 1
    s_add_u32 s14, s14, s3
    s_add_u32 s14, s14, 32
    s_lshl_b32 s14, s14, 16
    s_lshl_b32 s15, s4, 10
    s_add_u32 s14, s14, s15
    v_add_u32 v4, s14, v4
    v_mul_u32_u24 v5, 6912, v1
    s_mul_i32 s14, s3, 20
    s_add_u32 s14, s14, s5
    s_mul_i32 s56, s14, 57
    s_lshr_b32 s56, s56, 9
    s_mul_i32 s15, s56, 9
    s_sub_u32 s15, s14, s15
    s_mul_i32 s15, s15, 442368
    s_lshl_b32 s56, s56, 3
    s_add_u32 s56, s56, s4
    s_lshl_b32 s14, s56, 7
    s_add_u32 s14, s14, s15
    v_add_u32 v5, s14, v5
    s_waitcnt lgkmcnt(0)
    s_load_dword s55, s[44:45], 0
    s_add_u32 s64, s44, 524288
    s_addc_u32 s65, s45, 0
    s_cmp_ge_u32 s56, 18
    s_cbranch_scc1 L_assist_wq
    global_load_dword v125, v5, s[38:39]
L_assist_wq:
    global_load_dword v127, v4, s[22:23]
    s_branch L_role_att
L_role_x:
    s_mov_b32 s8, s3
    s_sub_u32 s12, s2, 224
    s_cmp_ge_u32 s3, 9
    s_cbranch_scc1 L_x_aux
    v_lshrrev_b32 v10, 3, v1
    v_mul_u32_u24 v10, 6912, v10
    v_and_b32 v7, 7, v1
    v_lshl_add_u32 v10, v7, 4, v10
    s_mul_i32 s58, s8, 442368
    s_lshl_b32 s56, s8, 13
    s_lshl_b32 s15, s12, 7
    s_add_u32 s14, s58, s15
    v_min_u32 v11, 287, v0
    v_lshlrev_b32 v11, 3, v11
    v_mov_b32 v4, v10
    s_waitcnt lgkmcnt(0)
    global_load_dwordx2 v[12:13], v11, s[36:37]
    s_add_u32 s46, s38, s14
    s_addc_u32 s47, s39, 0
    s_mov_b32 m0, s56
    s_nop 0
    global_load_lds_dwordx4 v4, s[46:47] offset:0 nt
    v_add_u32 v4, 54272, v4
    global_load_lds_dwordx4 v4, s[46:47] offset:1024 nt
    v_add_u32 v4, 54272, v4
    global_load_lds_dwordx4 v4, s[46:47] offset:2048 nt
    v_add_u32 v4, 54272, v4
    global_load_lds_dwordx4 v4, s[46:47] offset:3072 nt
    s_add_u32 m0, s56, 4096
    v_add_u32 v4, 58368, v4
    global_load_lds_dwordx4 v4, s[46:47] offset:0 nt
    v_add_u32 v4, 54272, v4
    global_load_lds_dwordx4 v4, s[46:47] offset:1024 nt
    v_add_u32 v4, 54272, v4
    global_load_lds_dwordx4 v4, s[46:47] offset:2048 nt
    v_add_u32 v4, 54272, v4
    global_load_lds_dwordx4 v4, s[46:47] offset:3072 nt
    s_load_dword s55, s[44:45], 0
    s_add_u32 s64, s44, 524288
    s_addc_u32 s65, s45, 0
    s_cmp_lt_u32 s12, 18
    s_cselect_b32 s14, 32, 30
    s_and_b32 s15, s12, 30
    s_cmp_eq_u32 s15, 16
    s_cselect_b32 s14, 99, s14
    s_add_u32 s62, s12, s14
    s_sub_u32 s57, s5, 28
    s_mul_i32 s57, s57, 9
    s_add_u32 s57, s57, s8
    s_cmp_ge_u32 s57, 27
    s_cselect_b32 s57, 1000, s57
    s_cmp_ge_u32 s3, 5
    s_cbranch_scc1 L_x_nosilu
    s_mov_b32 s14, 0xbfb8aa3b
    s_waitcnt vmcnt(8)
    v_lshlrev_b32 v24, 16, v12
    v_and_b32 v25, s54, v12
    v_lshlrev_b32 v26, 16, v13
    v_and_b32 v27, s54, v13
    v_mul_f32 v16, s14, v24
    v_mul_f32 v17, s14, v25
    v_mul_f32 v18, s14, v26
    v_mul_f32 v19, s14, v27
    v_exp_f32 v16, v16
    v_exp_f32 v17, v17
    v_exp_f32 v18, v18
    v_exp_f32 v19, v19
    v_add_f32 v16, 1.0, v16
    v_add_f32 v17, 1.0, v17
    v_add_f32 v18, 1.0, v18
    v_add_f32 v19, 1.0, v19
    v_rcp_f32 v16, v16
    v_rcp_f32 v17, v17
    v_rcp_f32 v18, v18
    v_rcp_f32 v19, v19
    v_mul_f32 v16, v16, v24
    v_mul_f32 v17, v17, v25
    v_mul_f32 v18, v18, v26
    v_mul_f32 v19, v19, v27
    v_cvt_pk_bf16_f32 v12, v16, v17
    v_cvt_pk_bf16_f32 v13, v18, v19
    v_add_u32 v11, 150528, v11
    ds_write_b64 v11, v[12:13]
L_x_nosilu:
    v_bfe_u32 v7, v1, 2, 2
    v_lshl_add_u32 v5, v3, 3, v7
    v_lshlrev_b32 v5, 7, v5
    v_and_b32 v7, 3, v1
    v_lshl_add_u32 v5, v7, 3, v5
    v_add_u32 v5, s56, v5
    v_and_b32 v7, 1, v1
    v_mul_u32_u24 v6, 1152, v7
    v_lshl_add_u32 v6, v3, 4, v6
    s_lshl_b32 s14, s8, 7
    s_add_u32 s14, s14, 150528
    v_add_u32 v6, s14, v6
    s_mul_i32 s14, s8, 512
    s_add_u32 s14, s14, 152832
    v_lshlrev_b32 v8, 3, v2
    v_add_u32 v8, s14, v8
    s_waitcnt lgkmcnt(0)
    s_barrier
    ds_read_b128 v[16:19], v6
    ds_read_b128 v[20:23], v6 offset:64
L_x_loop:
    s_waitcnt vmcnt(4)
    ds_read_b64_tr_b16 v[24:25], v5 offset:0
    ds_read_b64_tr_b16 v[26:27], v5 offset:512
    ds_read_b64_tr_b16 v[28:29], v5 offset:32
    ds_read_b64_tr_b16 v[30:31], v5 offset:544
    ds_read_b64_tr_b16 v[32:33], v5 offset:64
    ds_read_b64_tr_b16 v[34:35], v5 offset:576
    ds_read_b64_tr_b16 v[36:37], v5 offset:96
    ds_read_b64_tr_b16 v[38:39], v5 offset:608
    s_waitcnt vmcnt(0)
    ds_read_b64_tr_b16 v[40:41], v5 offset:4096
    ds_read_b64_tr_b16 v[42:43], v5 offset:4608
    ds_read_b64_tr_b16 v[44:45], v5 offset:4128
    ds_read_b64_tr_b16 v[46:47], v5 offset:4640
    ds_read_b64_tr_b16 v[48:49], v5 offset:4160
    ds_read_b64_tr_b16 v[50:51], v5 offset:4672
    ds_read_b64_tr_b16 v[52:53], v5 offset:4192
    ds_read_b64_tr_b16 v[54:55], v5 offset:4704
    s_waitcnt lgkmcnt(0)
    v_mfma_f32_16x16x32_bf16 v[56:59], v[16:19], v[24:27], 0
    v_mfma_f32_16x16x32_bf16 v[60:63], v[16:19], v[28:31], 0
    v_mfma_f32_16x16x32_bf16 v[64:67], v[16:19], v[32:35], 0
    v_mfma_f32_16x16x32_bf16 v[68:71], v[16:19], v[36:39], 0
    v_mfma_f32_16x16x32_bf16 v[56:59], v[20:23], v[40:43], v[56:59]
    v_mfma_f32_16x16x32_bf16 v[60:63], v[20:23], v[44:47], v[60:63]
    v_mfma_f32_16x16x32_bf16 v[64:67], v[20:23], v[48:51], v[64:67]
    v_mfma_f32_16x16x32_bf16 v[68:71], v[20:23], v[52:55], v[68:71]
    s_mov_b64 exec, 0xffff
    s_nop 3
    ds_write_b64 v8, v[56:57] offset:0
    ds_write_b64 v8, v[60:61] offset:128
    ds_write_b64 v8, v[64:65] offset:256
    ds_write_b64 v8, v[68:69] offset:384
    s_mov_b64 exec, -1
    s_lshl_b32 s15, s62, 7
    s_add_u32 s14, s58, s15
    s_add_u32 s46, s38, s14
    s_addc_u32 s47, s39, 0
    v_mov_b32 v4, v10
    s_waitcnt lgkmcnt(0)
    s_barrier
    s_barrier
    s_cmp_ge_u32 s62, 54
    s_cbranch_scc1 L_x_gdone
    s_mov_b32 s62, 99
    s_mov_b32 m0, s56
    s_nop 0
    global_load_lds_dwordx4 v4, s[46:47] offset:0 nt
    v_add_u32 v4, 54272, v4
    global_load_lds_dwordx4 v4, s[46:47] offset:1024 nt
    v_add_u32 v4, 54272, v4
    global_load_lds_dwordx4 v4, s[46:47] offset:2048 nt
    v_add_u32 v4, 54272, v4
    global_load_lds_dwordx4 v4, s[46:47] offset:3072 nt
    s_add_u32 m0, s56, 4096
    v_add_u32 v4, 58368, v4
    global_load_lds_dwordx4 v4, s[46:47] offset:0 nt
    v_add_u32 v4, 54272, v4
    global_load_lds_dwordx4 v4, s[46:47] offset:1024 nt
    v_add_u32 v4, 54272, v4
    global_load_lds_dwordx4 v4, s[46:47] offset:2048 nt
    v_add_u32 v4, 54272, v4
    global_load_lds_dwordx4 v4, s[46:47] offset:3072 nt
    s_branch L_x_loop
L_x_gdone:
    s_sub_u32 s58, 3, s4
    s_and_b32 s58, s58, 7
    s_sub_u32 s59, s5, 28
    s_lshl_b32 s59, s59, 3
    s_add_u32 s58, s58, s59
    s_cmp_ge_u32 s58, 9
    s_cbranch_scc1 L_pf3
    s_mul_i32 s59, s4, 9
    s_add_u32 s58, s58, s59
    s_lshl_b32 s58, s58, 7
    s_mul_i32 s59, s8, 589824
    s_add_u32 s58, s58, s59
    v_mul_u32_u24 v110, 9216, v1
    v_add_u32 v110, s58, v110
    global_load_dword v111, v110, s[28:29]
L_pf3:
    s_branch L_x_done
L_x_aux:
    s_waitcnt lgkmcnt(0)
    s_load_dword s55, s[44:45], 0
    s_add_u32 s64, s44, 524288
    s_addc_u32 s65, s45, 0
    s_cmp_eq_u32 s3, 9
    s_cbranch_scc1 L_x_reset
    s_cmp_lg_u32 s3, 10
    s_cbranch_scc1 L_x_bars
    s_cmp_lt_u32 s12, 18
    s_cselect_b32 s14, 32, 30
    s_and_b32 s15, s12, 30
    s_cmp_eq_u32 s15, 16
    s_cselect_b32 s14, 99, s14
    s_add_u32 s62, s12, s14
    s_waitcnt lgkmcnt(0)
    s_mul_i32 s10, s55, 1664525
    s_add_u32 s10, s10, 1013904223
    s_max_u32 s10, s10, 1
    v_lshlrev_b32 v5, 3, v1
    v_add_u32 v4, 152832, v5
    v_add_u32 v5, 4096, v5
    s_barrier
L_x_ploop:
    s_lshl_b32 s14, s12, 9
    v_add_u32 v6, s14, v5
    s_barrier
    ds_read_b64 v[24:25], v4 offset:0
    ds_read_b64 v[26:27], v4 offset:512
    ds_read_b64 v[28:29], v4 offset:1024
    ds_read_b64 v[30:31], v4 offset:1536
    ds_read_b64 v[32:33], v4 offset:2048
    ds_read_b64 v[34:35], v4 offset:2560
    ds_read_b64 v[36:37], v4 offset:3072
    ds_read_b64 v[38:39], v4 offset:3584
    ds_read_b64 v[40:41], v4 offset:4096
    s_waitcnt lgkmcnt(0)
    v_pk_add_f32 v[24:25], v[24:25], v[26:27]
    v_pk_add_f32 v[28:29], v[28:29], v[30:31]
    v_pk_add_f32 v[32:33], v[32:33], v[34:35]
    v_pk_add_f32 v[36:37], v[36:37], v[38:39]
    v_pk_add_f32 v[24:25], v[24:25], v[28:29]
    v_pk_add_f32 v[32:33], v[32:33], v[36:37]
    v_pk_add_f32 v[24:25], v[24:25], v[40:41]
    v_pk_add_f32 v[24:25], v[24:25], v[32:33]
    v_cvt_pk_bf16_f32 v24, v24, v25
    v_mov_b32 v25, s10
    global_store_dwordx2 v6, v[24:25], s[44:45] sc1
    s_barrier
    s_mov_b32 s12, s62
    s_mov_b32 s62, 99
    s_cmp_lt_u32 s12, 54
    s_cbranch_scc1 L_x_ploop
    s_branch L_x_done
L_x_reset:
    s_cmp_ge_u32 s12, 18
    s_cbranch_scc1 L_x_bars
    v_mov_b32 v8, -1
    v_mov_b32 v9, -1
    v_mov_b32 v10, -1
    v_mov_b32 v11, -1
    s_lshl_b32 s14, s12, 11
    s_add_u32 s14, s14, 327680
    v_lshl_add_u32 v4, v1, 4, s14
    global_store_dwordx4 v4, v[8:11], s[44:45] sc1
    global_store_dwordx4 v4, v[8:11], s[44:45] offset:1024 sc1
    s_lshl_b32 s14, s12, 10
    s_add_u32 s14, s14, 393216
    v_lshl_add_u32 v4, v1, 4, s14
    global_store_dwordx4 v4, v[8:11], s[44:45] sc1
    global_store_dwordx4 v4, v[8:11], s[64:65] sc1
    s_barrier
    s_waitcnt vmcnt(0)
    s_branch L_x_bars2
L_x_bars:
    s_barrier
L_x_bars2:
    s_barrier
    s_cmp_lg_u32 s5, 31
    s_cbranch_scc1 L_end
    s_barrier
L_x_done:
    s_cmp_lg_u32 s5, 31
    s_cbranch_scc1 L_end
    s_mov_b32 s12, 8
    s_branch L_wo
L_role_q:
    s_sub_u32 s12, s5, 20
    s_cmp_lt_u32 s3, 7
    s_cbranch_scc1 L_q_aux
    s_lshl_b32 s14, s8, 19
    s_lshl_b32 s15, s4, 10
    s_add_u32 s14, s14, s15
    s_lshl_b32 s15, s12, 7
    s_add_u32 s14, s14, s15
    v_lshrrev_b32 v4, 3, v1
    v_mul_u32_u24 v4, 8192, v4
    v_and_b32 v7, 7, v1
    v_lshl_add_u32 v4, v7, 4, v4
    s_lshl_b32 s15, s8, 13
    s_waitcnt lgkmcnt(0)
    s_add_u32 s46, s22, s14
    s_addc_u32 s47, s23, 0
    s_mov_b32 m0, s15
    s_nop 0
    global_load_lds_dwordx4 v4, s[46:47] offset:0 nt
    v_add_u32 v4, 64512, v4
    global_load_lds_dwordx4 v4, s[46:47] offset:1024 nt
    v_add_u32 v4, 64512, v4
    global_load_lds_dwordx4 v4, s[46:47] offset:2048 nt
    v_add_u32 v4, 64512, v4
    global_load_lds_dwordx4 v4, s[46:47] offset:3072 nt
    s_add_u32 m0, s15, 4096
    v_add_u32 v4, 68608, v4
    global_load_lds_dwordx4 v4, s[46:47] offset:0 nt
    v_add_u32 v4, 64512, v4
    global_load_lds_dwordx4 v4, s[46:47] offset:1024 nt
    v_add_u32 v4, 64512, v4
    global_load_lds_dwordx4 v4, s[46:47] offset:2048 nt
    v_add_u32 v4, 64512, v4
    global_load_lds_dwordx4 v4, s[46:47] offset:3072 nt
    s_load_dword s55, s[44:45], 0
    s_add_u32 s64, s44, 524288
    s_addc_u32 s65, s45, 0
    s_mov_b32 s57, s15
    s_barrier
    v_bfe_u32 v7, v1, 2, 2
    v_lshl_add_u32 v5, v3, 3, v7
    v_lshlrev_b32 v5, 7, v5
    v_and_b32 v7, 3, v1
    v_lshl_add_u32 v5, v7, 3, v5
    v_add_u32 v5, s57, v5
    v_and_b32 v7, 1, v1
    v_mul_u32_u24 v6, 1152, v7
    v_lshl_add_u32 v6, v3, 4, v6
    s_lshl_b32 s14, s8, 7
    s_add_u32 s14, s14, 150528
    v_add_u32 v6, s14, v6
    s_mul_i32 s14, s8, 512
    s_add_u32 s14, s14, 152832
    v_mul_u32_u24 v8, 256, v2
    v_lshl_add_u32 v8, v3, 4, v8
    v_add_u32 v8, s14, v8
    s_waitcnt vmcnt(0)
    ds_read_b64_tr_b16 v[24:25], v5 offset:0
    ds_read_b64_tr_b16 v[26:27], v5 offset:512
    ds_read_b64_tr_b16 v[28:29], v5 offset:32
    ds_read_b64_tr_b16 v[30:31], v5 offset:544
    ds_read_b64_tr_b16 v[32:33], v5 offset:64
    ds_read_b64_tr_b16 v[34:35], v5 offset:576
    ds_read_b64_tr_b16 v[36:37], v5 offset:96
    ds_read_b64_tr_b16 v[38:39], v5 offset:608
    ds_read_b64_tr_b16 v[40:41], v5 offset:4096
    ds_read_b64_tr_b16 v[42:43], v5 offset:4608
    ds_read_b64_tr_b16 v[44:45], v5 offset:4128
    ds_read_b64_tr_b16 v[46:47], v5 offset:4640
    ds_read_b64_tr_b16 v[48:49], v5 offset:4160
    ds_read_b64_tr_b16 v[50:51], v5 offset:4672
    ds_read_b64_tr_b16 v[52:53], v5 offset:4192
    ds_read_b64_tr_b16 v[54:55], v5 offset:4704
    s_waitcnt lgkmcnt(0)
    s_barrier
    ds_read_b128 v[16:19], v6
    ds_read_b128 v[20:23], v6 offset:64
    s_waitcnt lgkmcnt(0)
    v_mfma_f32_16x16x32_bf16 v[56:59], v[24:27], v[16:19], 0
    v_mfma_f32_16x16x32_bf16 v[60:63], v[28:31], v[16:19], 0
    v_mfma_f32_16x16x32_bf16 v[64:67], v[32:35], v[16:19], 0
    v_mfma_f32_16x16x32_bf16 v[68:71], v[36:39], v[16:19], 0
    v_mfma_f32_16x16x32_bf16 v[56:59], v[40:43], v[20:23], v[56:59]
    v_mfma_f32_16x16x32_bf16 v[60:63], v[44:47], v[20:23], v[60:63]
    v_mfma_f32_16x16x32_bf16 v[64:67], v[48:51], v[20:23], v[64:67]
    v_mfma_f32_16x16x32_bf16 v[68:71], v[52:55], v[20:23], v[68:71]
    s_mov_b32 exec_lo, 0x00030003
    s_mov_b32 exec_hi, 0x00030003
    s_nop 2
    ds_write_b128 v8, v[56:59] offset:0
    ds_write_b128 v8, v[60:63] offset:64
    ds_write_b128 v8, v[64:67] offset:128
    ds_write_b128 v8, v[68:71] offset:192
    s_mov_b64 exec, -1
    s_waitcnt lgkmcnt(0)
    s_branch L_q_b2
L_q_aux:
    s_waitcnt lgkmcnt(0)
    s_load_dword s55, s[44:45], 0
    s_add_u32 s64, s44, 524288
    s_addc_u32 s65, s45, 0
    s_cmp_lt_u32 s3, 5
    s_cbranch_scc1 L_q_h
    s_cmp_eq_u32 s3, 5
    s_cbranch_scc1 L_q_reset
    s_waitcnt lgkmcnt(0)
    s_mul_i32 s10, s55, 1664525
    s_add_u32 s10, s10, 1013904223
    s_max_u32 s10, s10, 1
    s_lshl_b32 s14, s4, 12
    s_lshr_b32 s15, s12, 2
    s_lshl_b32 s15, s15, 11
    s_add_u32 s14, s14, s15
    s_and_b32 s15, s12, 3
    s_lshl_b32 s15, s15, 8
    s_add_u32 s14, s14, s15
    s_add_u32 s14, s14, 32768
    v_lshrrev_b32 v6, 5, v1
    v_lshlrev_b32 v6, 10, v6
    v_and_b32 v5, 31, v1
    v_lshl_add_u32 v6, v5, 3, v6
    v_add_u32 v6, s14, v6
    v_lshlrev_b32 v4, 3, v1
    v_add_u32 v4, 152832, v4
    s_barrier
    s_barrier
    s_barrier
    ds_read_b64 v[24:25], v4 offset:0
    ds_read_b64 v[26:27], v4 offset:512
    ds_read_b64 v[28:29], v4 offset:1024
    ds_read_b64 v[30:31], v4 offset:1536
    ds_read_b64 v[32:33], v4 offset:2048
    ds_read_b64 v[34:35], v4 offset:2560
    ds_read_b64 v[36:37], v4 offset:3072
    ds_read_b64 v[38:39], v4 offset:3584
    ds_read_b64 v[40:41], v4 offset:4096
    s_waitcnt lgkmcnt(0)
    v_pk_add_f32 v[24:25], v[24:25], v[26:27]
    v_pk_add_f32 v[28:29], v[28:29], v[30:31]
    v_pk_add_f32 v[32:33], v[32:33], v[34:35]
    v_pk_add_f32 v[36:37], v[36:37], v[38:39]
    v_pk_add_f32 v[24:25], v[24:25], v[28:29]
    v_pk_add_f32 v[32:33], v[32:33], v[36:37]
    v_pk_add_f32 v[24:25], v[24:25], v[40:41]
    v_pk_add_f32 v[24:25], v[24:25], v[32:33]
    v_cvt_pk_bf16_f32 v24, v24, v25
    v_mov_b32 v25, s10
    global_store_dwordx2 v6, v[24:25], s[64:65]
    global_store_dwordx2 v6, v[24:25], s[44:45] sc1
    s_branch L_q_b3
L_q_reset:
    v_mov_b32 v8, -1
    v_mov_b32 v9, -1
    v_mov_b32 v10, -1
    v_mov_b32 v11, -1
    s_lshl_b32 s14, s4, 3
    s_add_u32 s14, s14, s12
    s_mul_i32 s14, s14, 2560
    s_add_u32 s14, s14, 131072
    v_lshl_add_u32 v4, v1, 4, s14
    global_store_dwordx4 v4, v[8:11], s[44:45] sc1
    global_store_dwordx4 v4, v[8:11], s[44:45] offset:1024 sc1
    global_store_dwordx4 v4, v[8:11], s[64:65] sc1
    global_store_dwordx4 v4, v[8:11], s[64:65] offset:1024 sc1
    s_mov_b32 exec_hi, 0
    global_store_dwordx4 v4, v[8:11], s[44:45] offset:2048 sc1
    global_store_dwordx4 v4, v[8:11], s[64:65] offset:2048 sc1
    s_mov_b64 exec, -1
    s_nop 0
    v_mul_u32_u24 v4, 6912, v1
    s_waitcnt vmcnt(0)
    s_barrier
    s_branch L_q_b1
L_q_h:
    v_mov_b32 v14, v0
    v_lshrrev_b32 v4, 5, v1
    v_mul_u32_u24 v4, 1152, v4
    v_and_b32 v5, 31, v1
    v_mul_u32_u24 v5, 36, v5
    v_add_u32 v4, v4, v5
    global_load_dwordx3 v[16:18], v4, s[16:17] offset:0
    global_load_dwordx3 v[20:22], v4, s[16:17] offset:12
    global_load_dwordx3 v[24:26], v4, s[16:17] offset:24
    v_min_u32 v5, 287, v14
    v_lshlrev_b32 v5, 2, v5
    global_load_dword v12, v5, s[16:17]
    global_load_dword v13, v5, s[16:17] offset:1152
    s_waitcnt vmcnt(2)
    v_lshlrev_b32 v32, 16, v16
    v_and_b32 v33, s54, v16
    v_lshlrev_b32 v34, 16, v17
    v_and_b32 v35, s54, v17
    v_lshlrev_b32 v36, 16, v18
    v_and_b32 v37, s54, v18
    v_lshlrev_b32 v38, 16, v20
    v_and_b32 v39, s54, v20
    v_lshlrev_b32 v40, 16, v21
    v_and_b32 v41, s54, v21
    v_lshlrev_b32 v42, 16, v22
    v_and_b32 v43, s54, v22
    v_lshlrev_b32 v44, 16, v24
    v_and_b32 v45, s54, v24
    v_lshlrev_b32 v46, 16, v25
    v_and_b32 v47, s54, v25
    v_lshlrev_b32 v48, 16, v26
    v_and_b32 v49, s54, v26
    v_add_f32 v8, v32, v33
    v_add_f32 v8, v8, v34
    v_add_f32 v8, v8, v35
    v_add_f32 v8, v8, v36
    v_add_f32 v8, v8, v37
    v_add_f32 v8, v8, v38
    v_add_f32 v8, v8, v39
    v_add_f32 v8, v8, v40
    v_add_f32 v8, v8, v41
    v_add_f32 v8, v8, v42
    v_add_f32 v8, v8, v43
    v_add_f32 v8, v8, v44
    v_add_f32 v8, v8, v45
    v_add_f32 v8, v8, v46
    v_add_f32 v8, v8, v47
    v_add_f32 v8, v8, v48
    v_add_f32 v8, v8, v49
    s_nop 1
    v_add_f32_dpp v8, v8, v8 row_ror:8 row_mask:0xf bank_mask:0xf
    s_nop 1
    v_add_f32_dpp v8, v8, v8 row_ror:4 row_mask:0xf bank_mask:0xf
    s_nop 1
    v_add_f32_dpp v8, v8, v8 row_ror:2 row_mask:0xf bank_mask:0xf
    s_nop 1
    v_add_f32_dpp v8, v8, v8 row_ror:1 row_mask:0xf bank_mask:0xf
    v_mov_b32 v9, v8
    s_nop 1
    v_permlane16_swap_b32 v8, v9
    v_add_f32 v8, v8, v9
    s_mov_b32 s14, 0x3ae38e39
    v_mul_f32 v8, s14, v8
    v_mov_b32 v10, 0
    v_sub_f32 v9, v32, v8
    v_fmac_f32 v10, v9, v9
    v_sub_f32 v9, v33, v8
    v_fmac_f32 v10, v9, v9
    v_sub_f32 v9, v34, v8
    v_fmac_f32 v10, v9, v9
    v_sub_f32 v9, v35, v8
    v_fmac_f32 v10, v9, v9
    v_sub_f32 v9, v36, v8
    v_fmac_f32 v10, v9, v9
    v_sub_f32 v9, v37, v8
    v_fmac_f32 v10, v9, v9
    v_sub_f32 v9, v38, v8
    v_fmac_f32 v10, v9, v9
    v_sub_f32 v9, v39, v8
    v_fmac_f32 v10, v9, v9
    v_sub_f32 v9, v40, v8
    v_fmac_f32 v10, v9, v9
    v_sub_f32 v9, v41, v8
    v_fmac_f32 v10, v9, v9
    v_sub_f32 v9, v42, v8
    v_fmac_f32 v10, v9, v9
    v_sub_f32 v9, v43, v8
    v_fmac_f32 v10, v9, v9
    v_sub_f32 v9, v44, v8
    v_fmac_f32 v10, v9, v9
    v_sub_f32 v9, v45, v8
    v_fmac_f32 v10, v9, v9
    v_sub_f32 v9, v46, v8
    v_fmac_f32 v10, v9, v9
    v_sub_f32 v9, v47, v8
    v_fmac_f32 v10, v9, v9
    v_sub_f32 v9, v48, v8
    v_fmac_f32 v10, v9, v9
    v_sub_f32 v9, v49, v8
    v_fmac_f32 v10, v9, v9
    s_nop 1
    v_add_f32_dpp v10, v10, v10 row_ror:8 row_mask:0xf bank_mask:0xf
    s_nop 1
    v_add_f32_dpp v10, v10, v10 row_ror:4 row_mask:0xf bank_mask:0xf
    s_nop 1
    v_add_f32_dpp v10, v10, v10 row_ror:2 row_mask:0xf bank_mask:0xf
    s_nop 1
    v_add_f32_dpp v10, v10, v10 row_ror:1 row_mask:0xf bank_mask:0xf
    v_mov_b32 v9, v10
    s_nop 1
    v_permlane16_swap_b32 v10, v9
    v_add_f32 v10, v10, v9
    v_mul_f32 v10, s14, v10
    v_cvt_pk_bf16_f32 v9, v8, v10
    v_lshlrev_b32 v8, 16, v9
    v_and_b32 v10, s54, v9
    v_add_f32 v10, 0x3727c5ac, v10
    v_cvt_pk_bf16_f32 v9, v10, v10
    v_lshlrev_b32 v10, 16, v9
    v_and_b32 v11, s54, v9
    v_sqrt_f32 v10, v10
    s_nop 0
    v_cvt_pk_bf16_f32 v9, v10, v10
    v_lshlrev_b32 v10, 16, v9
    v_and_b32 v11, s54, v9
    v_rcp_f32 v10, v10
    v_readlane_b32 s56, v8, 0
    v_readlane_b32 s57, v8, 32
    v_readlane_b32 s58, v10, 0
    v_readlane_b32 s59, v10, 32
    s_waitcnt vmcnt(0)
    v_lshlrev_b32 v16, 16, v12
    v_and_b32 v17, s54, v12
    v_lshlrev_b32 v18, 16, v13
    v_and_b32 v19, s54, v13
    v_subrev_f32 v16, s56, v16
    v_subrev_f32 v17, s56, v17
    v_subrev_f32 v18, s57, v18
    v_subrev_f32 v19, s57, v19
    v_cvt_pk_bf16_f32 v9, v16, v17
    v_lshlrev_b32 v16, 16, v9
    v_and_b32 v17, s54, v9
    v_cvt_pk_bf16_f32 v9, v18, v19
    v_lshlrev_b32 v18, 16, v9
    v_and_b32 v19, s54, v9
    v_mul_f32 v16, s58, v16
    v_mul_f32 v17, s58, v17
    v_mul_f32 v18, s59, v18
    v_mul_f32 v19, s59, v19
    v_cvt_pk_bf16_f32 v9, v16, v17
    v_lshlrev_b32 v16, 16, v9
    v_and_b32 v17, s54, v9
    v_cvt_pk_bf16_f32 v9, v18, v19
    v_lshlrev_b32 v18, 16, v9
    v_and_b32 v19, s54, v9
    s_waitcnt lgkmcnt(0)
    s_mul_i32 s10, s55, 1664525
    s_add_u32 s10, s10, 1013904223
    s_max_u32 s10, s10, 1
    v_cmp_gt_u32 vcc, 288, v14
    s_nop 0
    s_mov_b64 exec, vcc
    s_mov_b64 s[50:51], vcc
    v_lshlrev_b32 v4, 4, v14
    v_add_u32 v4, 4096, v4
    v_add_u32 v5, 4608, v4
    v_lshlrev_b32 v6, 2, v14
    v_add_u32 v6, 150528, v6
    s_barrier
L_poll_h1:
    global_load_dwordx4 v[20:23], v4, s[44:45] sc1
    global_load_dwordx4 v[24:27], v5, s[44:45] sc1
    s_waitcnt vmcnt(0)
    v_xor_b32 v8, s10, v21
    v_xor_b32 v9, s10, v23
    v_or_b32 v8, v8, v9
    v_xor_b32 v9, s10, v25
    v_or_b32 v8, v8, v9
    v_xor_b32 v9, s10, v27
    v_or_b32 v8, v8, v9
    v_cmp_ne_u32 vcc, 0, v8
    s_cbranch_vccz L_poll_h1_ok
    s_mov_b64 exec, vcc
    s_sub_u32 s13, s13, 1
    s_cbranch_scc0 L_poll_h1
    s_branch L_end
L_poll_h1_ok:
    s_mov_b64 exec, s[50:51]
    v_lshlrev_b32 v8, 16, v24
    v_lshlrev_b32 v9, 16, v26
    v_and_b32 v10, s54, v24
    v_and_b32 v11, s54, v26
    v_add_f32 v8, 1.0, v8
    v_add_f32 v9, 1.0, v9
    v_add_f32 v10, 1.0, v10
    v_add_f32 v11, 1.0, v11
    v_cvt_pk_bf16_f32 v12, v8, v9
    v_lshlrev_b32 v8, 16, v12
    v_and_b32 v9, s54, v12
    v_cvt_pk_bf16_f32 v13, v10, v11
    v_lshlrev_b32 v10, 16, v13
    v_and_b32 v11, s54, v13
    v_mul_f32 v8, v8, v16
    v_mul_f32 v9, v9, v17
    v_mul_f32 v10, v10, v18
    v_mul_f32 v11, v11, v19
    v_cvt_pk_bf16_f32 v12, v8, v9
    v_lshlrev_b32 v8, 16, v12
    v_and_b32 v9, s54, v12
    v_cvt_pk_bf16_f32 v13, v10, v11
    v_lshlrev_b32 v10, 16, v13
    v_and_b32 v11, s54, v13
    v_lshlrev_b32 v16, 16, v20
    v_lshlrev_b32 v17, 16, v22
    v_and_b32 v18, s54, v20
    v_and_b32 v19, s54, v22
    v_add_f32 v8, v8, v16
    v_add_f32 v9, v9, v17
    v_add_f32 v10, v10, v18
    v_add_f32 v11, v11, v19
    v_cvt_pk_bf16_f32 v8, v8, v9
    v_cvt_pk_bf16_f32 v10, v10, v11
    ds_write_b32 v6, v8
    ds_write_b32 v6, v10 offset:1152
    s_mov_b64 exec, -1
    s_waitcnt lgkmcnt(0)
L_q_b1:
    s_barrier
L_q_b2:
    s_barrier
L_q_b3:
    s_barrier
L_wo:
    s_lshl_b32 s14, s4, 4
    s_add_u32 s14, s14, s3
    s_mul_i32 s14, s14, 36864
    s_lshl_b32 s15, s12, 7
    s_add_u32 s14, s14, s15
    s_add_u32 s46, s24, s14
    s_addc_u32 s47, s25, 0
    v_lshrrev_b32 v4, 3, v1
    v_mul_u32_u24 v4, 1152, v4
    v_and_b32 v7, 7, v1
    v_lshl_add_u32 v4, v7, 4, v4
    s_lshl_b32 s15, s3, 12
    s_add_u32 s15, s15, 73728
    s_mov_b32 m0, s15
    s_nop 0
    global_load_lds_dwordx4 v4, s[46:47] offset:0 nt
    v_add_u32 v4, 8192, v4
    global_load_lds_dwordx4 v4, s[46:47] offset:1024 nt
    v_add_u32 v4, 8192, v4
    global_load_lds_dwordx4 v4, s[46:47] offset:2048 nt
    v_add_u32 v4, 8192, v4
    global_load_lds_dwordx4 v4, s[46:47] offset:3072 nt
L_wo_skip:
    v_bfe_u32 v7, v1, 2, 2
    v_lshl_add_u32 v64, v3, 3, v7
    v_lshlrev_b32 v64, 7, v64
    v_and_b32 v7, 3, v1
    v_lshl_add_u32 v64, v7, 3, v64
    v_add_u32 v64, s15, v64
    s_waitcnt lgkmcnt(0)
    s_mul_i32 s10, s55, 1664525
    s_add_u32 s10, s10, 1013904223
    s_max_u32 s10, s10, 1
    s_lshl_b32 s14, s4, 1
    s_lshr_b32 s15, s3, 3
    s_add_u32 s58, s14, s15
    s_lshl_b32 s14, s58, 11
    s_add_u32 s14, s14, 32768
    v_and_b32 v63, 3, v1
    v_lshl_add_u32 v63, v63, 8, s14
    s_mul_i32 s14, s58, 10240
    s_add_u32 s14, s14, 131072
    s_bfe_u32 s56, s3, 0x10002
    v_lshlrev_b32 v5, 2, v3
    v_xor_b32 v5, v5, v2
    v_and_b32 v7, 7, v5
    v_cmp_gt_u32 s[50:51], 5, v7
    v_and_b32 v7, 8, v5
    s_nop 0
    v_cndmask_b32 v5, v7, v5, s[50:51]
    v_mul_u32_u24 v5, 640, v5
    s_lshl_b32 s57, s56, 3
    s_add_u32 s57, s57, s14
    v_add_u32 v5, s57, v5
    v_and_b32 v7, 7, v2
    v_cmp_gt_u32 vcc, 5, v7
    v_and_b32 v7, 8, v2
    s_nop 0
    v_cndmask_b32 v4, v7, v2, vcc
    v_mul_u32_u24 v4, 640, v4
    v_lshl_add_u32 v4, v3, 4, v4
    s_and_b32 s15, s3, 7
    s_lshl_b32 s15, s15, 6
    s_add_u32 s14, s14, s15
    v_add_u32 v4, s14, v4
    v_lshlrev_b32 v6, 4, v0
    s_lshl_b32 s14, s3, 9
    v_lshl_add_u32 v60, v1, 2, s14
    s_mul_i32 s14, s4, 4608
    s_mul_i32 s15, s3, 2304
    s_add_u32 s14, s14, s15
    s_lshl_b32 s15, s12, 8
    s_add_u32 s14, s14, s15
    s_add_u32 s14, s14, 327680
    v_and_b32 v61, 3, v1
    v_lshlrev_b32 v61, 6, v61
    v_and_b32 v62, 60, v1
    v_add3_u32 v61, v61, v62, s14
    s_mov_b32 s14, 0x3fb8aa3b
    s_mov_b64 exec, 15
L_poll_qt:
    global_load_dword v8, v63, s[44:45] offset:4 sc1
    s_waitcnt vmcnt(0)
    v_cmp_ne_u32 vcc, s10, v8
    s_cbranch_vccz L_poll_qt_ok
    s_mov_b64 exec, vcc
    s_sub_u32 s13, s13, 1
    s_cbranch_scc0 L_poll_qt
    s_branch L_end
L_poll_qt_ok:
    s_mov_b64 exec, -1
    ds_read_b64_tr_b16 v[112:113], v64 offset:0
    ds_read_b64_tr_b16 v[114:115], v64 offset:512
    ds_read_b64_tr_b16 v[116:117], v64 offset:32
    ds_read_b64_tr_b16 v[118:119], v64 offset:544
    ds_read_b64_tr_b16 v[120:121], v64 offset:64
    ds_read_b64_tr_b16 v[122:123], v64 offset:576
    ds_read_b64_tr_b16 v[124:125], v64 offset:96
    ds_read_b64_tr_b16 v[126:127], v64 offset:608
    s_or_b32 s13, s13, 63
L_poll_st:
    s_and_b32 s59, s13, 63
    s_cselect_b64 s[66:67], s[64:65], s[44:45]
    global_load_dwordx2 v[12:13], v5, s[66:67] offset:512 sc1
    s_waitcnt vmcnt(0)
    v_max_u32 v7, v12, v13
    v_cmp_eq_u32 vcc, -1, v7
    s_cbranch_vccz L_poll_st_ok
    s_mov_b64 exec, vcc
    s_sleep 2
    s_sub_u32 s13, s13, 1
    s_cbranch_scc0 L_poll_st
    s_branch L_end
L_poll_st_ok:
    s_mov_b64 exec, -1
    v_cndmask_b32 v13, 0, v13, s[50:51]
    v_max_f32_dpp v14, v12, v12 quad_perm:[1,0,3,2] row_mask:0xf bank_mask:0xf
    s_nop 1
    v_max_f32_dpp v14, v14, v14 quad_perm:[2,3,0,1] row_mask:0xf bank_mask:0xf
    s_nop 1
    v_max_f32_dpp v14, v14, v14 row_half_mirror row_mask:0xf bank_mask:0xf
    v_sub_f32 v12, v12, v14
    v_mul_f32 v12, s14, v12
    v_exp_f32 v12, v12
    s_nop 0
    v_mul_f32 v12, v12, v13
    s_nop 1
    v_add_f32_dpp v14, v12, v12 quad_perm:[1,0,3,2] row_mask:0xf bank_mask:0xf
    s_nop 1
    v_add_f32_dpp v14, v14, v14 quad_perm:[2,3,0,1] row_mask:0xf bank_mask:0xf
    s_nop 1
    v_add_f32_dpp v14, v14, v14 row_half_mirror row_mask:0xf bank_mask:0xf
    v_rcp_f32 v14, v14
    s_nop 0
    v_mul_f32 v12, v12, v14
    s_nop 1
    v_mov_b32_dpp v56, v12 row_newbcast:0 row_mask:0xf bank_mask:0xf
    v_mov_b32_dpp v57, v12 row_newbcast:1 row_mask:0xf bank_mask:0xf
    v_mov_b32_dpp v58, v12 row_newbcast:2 row_mask:0xf bank_mask:0xf
    v_mov_b32_dpp v59, v12 row_newbcast:3 row_mask:0xf bank_mask:0xf
    s_waitcnt lgkmcnt(0)
    s_or_b32 s13, s13, 63
L_poll_h3:
    s_and_b32 s59, s13, 63
    s_cselect_b64 s[66:67], s[64:65], s[44:45]
    global_load_dwordx4 v[8:11], v4, s[66:67] sc1
L_h3_chk:
    s_waitcnt vmcnt(0)
    v_max3_u32 v7, v8, v9, v10
    v_max_u32 v7, v7, v11
    v_cmp_eq_u32 vcc, -1, v7
    s_cbranch_vccz L_poll_h3_ok
    s_mov_b64 exec, vcc
    s_sub_u32 s13, s13, 1
    s_cbranch_scc0 L_poll_h3
    s_branch L_end
L_poll_h3_ok:
    s_mov_b64 exec, -1
    s_waitcnt lgkmcnt(0)
    v_mfma_f32_16x16x32_bf16 v[16:19], v[8:11], v[112:115], 0
    v_mfma_f32_16x16x32_bf16 v[20:23], v[8:11], v[116:119], 0
    v_mfma_f32_16x16x32_bf16 v[24:27], v[8:11], v[120:123], 0
    v_mfma_f32_16x16x32_bf16 v[28:31], v[8:11], v[124:127], 0
    s_nop 4
    v_mul_f32 v32, v56, v16
    v_mul_f32 v33, v56, v20
    v_mul_f32 v34, v56, v24
    v_mul_f32 v35, v56, v28
    v_fmac_f32 v32, v57, v17
    v_fmac_f32 v33, v57, v21
    v_fmac_f32 v34, v57, v25
    v_fmac_f32 v35, v57, v29
    v_fmac_f32 v32, v58, v18
    v_fmac_f32 v33, v58, v22
    v_fmac_f32 v34, v58, v26
    v_fmac_f32 v35, v58, v30
    v_fmac_f32 v32, v59, v19
    v_fmac_f32 v33, v59, v23
    v_fmac_f32 v34, v59, v27
    v_fmac_f32 v35, v59, v31
    ds_write_b128 v6, v[32:35]
    s_waitcnt lgkmcnt(0)
    s_barrier
    s_cmp_ge_u32 s3, 2
    s_cbranch_scc1 L_end
    ds_read2st64_b32 v[16:17], v60 offset0:0 offset1:1
    ds_read2st64_b32 v[18:19], v60 offset0:4 offset1:5
    ds_read2st64_b32 v[20:21], v60 offset0:8 offset1:9
    ds_read2st64_b32 v[22:23], v60 offset0:12 offset1:13
    ds_read2st64_b32 v[24:25], v60 offset0:16 offset1:17
    ds_read2st64_b32 v[26:27], v60 offset0:20 offset1:21
    ds_read2st64_b32 v[28:29], v60 offset0:24 offset1:25
    ds_read2st64_b32 v[30:31], v60 offset0:28 offset1:29
    ds_read2st64_b32 v[32:33], v60 offset0:32 offset1:33
    ds_read2st64_b32 v[34:35], v60 offset0:36 offset1:37
    ds_read2st64_b32 v[36:37], v60 offset0:40 offset1:41
    ds_read2st64_b32 v[38:39], v60 offset0:44 offset1:45
    ds_read2st64_b32 v[40:41], v60 offset0:48 offset1:49
    ds_read2st64_b32 v[42:43], v60 offset0:52 offset1:53
    ds_read2st64_b32 v[44:45], v60 offset0:56 offset1:57
    ds_read2st64_b32 v[46:47], v60 offset0:60 offset1:61
    s_waitcnt lgkmcnt(0)
    v_pk_add_f32 v[16:17], v[16:17], v[18:19]
    v_pk_add_f32 v[20:21], v[20:21], v[22:23]
    v_pk_add_f32 v[24:25], v[24:25], v[26:27]
    v_pk_add_f32 v[28:29], v[28:29], v[30:31]
    v_pk_add_f32 v[32:33], v[32:33], v[34:35]
    v_pk_add_f32 v[36:37], v[36:37], v[38:39]
    v_pk_add_f32 v[40:41], v[40:41], v[42:43]
    v_pk_add_f32 v[44:45], v[44:45], v[46:47]
    v_pk_add_f32 v[16:17], v[16:17], v[20:21]
    v_pk_add_f32 v[24:25], v[24:25], v[28:29]
    v_pk_add_f32 v[32:33], v[32:33], v[36:37]
    v_pk_add_f32 v[40:41], v[40:41], v[44:45]
    v_pk_add_f32 v[16:17], v[16:17], v[24:25]
    v_pk_add_f32 v[32:33], v[32:33], v[40:41]
    v_pk_add_f32 v[16:17], v[16:17], v[32:33]
    v_add_f32 v16, v16, v17
    v_min_u32 v16, -2, v16
    global_store_dword v61, v16, s[44:45] sc1
    s_branch L_end
L_role_att:
    s_mul_i32 s6, s5, 13
    s_lshr_b32 s6, s6, 6
    s_mul_i32 s14, s6, 5
    s_sub_u32 s7, s5, s14
    s_cmp_eq_u32 s7, 4
    s_cselect_b32 s9, 12, 13
    s_mul_i32 s12, s4, 18
    s_add_u32 s12, s12, s5
    s_cmp_lt_u32 s3, 2
    s_cbranch_scc1 L_att_special
    s_cmp_lt_u32 s3, 9
    s_cselect_b32 s14, 2, 9
    s_sub_u32 s63, s3, s14
    s_lshl_b32 s57, s63, 1
    s_sub_u32 s11, s9, s57
    s_min_u32 s11, s11, 2
    s_and_b32 s14, s6, 1
    s_lshl_b32 s14, s14, 3
    s_add_u32 s14, s14, s4
    s_lshl_b32 s14, s14, 1
    s_lshr_b32 s15, s6, 1
    s_add_u32 s14, s14, s15
    s_lshl_b32 s14, s14, 21
    s_mul_i32 s15, s57, 5
    s_cmp_eq_u32 s63, 6
    s_cselect_b32 s59, 0, s7
    s_add_u32 s15, s15, s59
    s_add_u32 s15, s15, s7
    s_lshl_b32 s15, s15, 13
    s_add_u32 s14, s14, s15
    s_add_u32 s58, s14, 1572864
    s_cmp_ge_u32 s3, 9
    s_cbranch_scc1 L_vwave
    s_lshl_b32 s59, s63, 14
    v_xor_b32 v4, v2, v3
    v_lshlrev_b32 v4, 4, v4
    v_lshl_add_u32 v12, v3, 8, v4
    v_xor_b32 v13, 64, v12
    v_xor_b32 v14, 128, v12
    v_xor_b32 v15, 192, v12
    v_mov_b32 v112, 146720
    s_lshl_b32 s14, s4, 2
    s_add_u32 s14, s14, s6
    s_lshl_b32 s14, s14, 10
    s_add_u32 s14, s14, 32768
    v_lshl_add_u32 v113, v1, 4, s14
    s_sub_u32 s60, s3, 2
    s_mov_b32 s61, 0
    s_waitcnt lgkmcnt(0)
    s_load_dword s55, s[44:45], 0
    s_add_u32 s64, s44, 524288
    s_addc_u32 s65, s45, 0
    s_add_u32 s46, s18, s58
    s_addc_u32 s47, s19, 0
    s_barrier
    s_cmp_lt_u32 s60, 1
    s_cbranch_scc1 L_ktok_go
L_ktok:
    ds_read_b128 v[116:119], v112
    s_waitcnt lgkmcnt(0)
    v_cmp_ne_u32 vcc, s60, v117
    s_cbranch_vccz L_ktok_ok
    s_sleep 3
    s_sub_u32 s13, s13, 1
    s_cbranch_scc0 L_ktok
    s_branch L_end
L_ktok_ok:
    v_readfirstlane_b32 s61, v116
    s_nop 0
    s_xor_b32 s61, s61, 1
    s_cmp_ge_u32 s60, 4
    s_cselect_b32 s61, s61, 0
L_ktok_go:
    s_cmp_eq_u32 s11, 0
    s_cbranch_scc1 L_k_issued
    s_cmp_eq_u32 s61, 0
    s_cbranch_scc1 L_kp0
    s_mov_b32 m0, 147456
    s_nop 0
    global_load_lds_dwordx4 v113, s[64:65] sc1
L_kp0:
    s_add_u32 m0, s59, 0
    s_nop 0
    global_load_lds_dwordx4 v12, s[46:47] offset:0 nt
    global_load_lds_dwordx4 v13, s[46:47] offset:1024 nt
    global_load_lds_dwordx4 v14, s[46:47] offset:2048 nt
    global_load_lds_dwordx4 v15, s[46:47] offset:3072 nt
    s_add_u32 m0, s59, 4096
    s_add_u32 s46, s46, 4096
    s_addc_u32 s47, s47, 0
    global_load_lds_dwordx4 v12, s[46:47] offset:0 nt
    global_load_lds_dwordx4 v13, s[46:47] offset:1024 nt
    global_load_lds_dwordx4 v14, s[46:47] offset:2048 nt
    global_load_lds_dwordx4 v15, s[46:47] offset:3072 nt
    s_cmp_lt_u32 s11, 2
    s_cbranch_scc1 L_k_issued
    s_cmp_eq_u32 s61, 0
    s_cbranch_scc1 L_kp2
    s_mov_b32 m0, 147456
    s_nop 0
    global_load_lds_dwordx4 v113, s[64:65] sc1
L_kp2:
    s_add_u32 m0, s59, 8192
    s_add_u32 s46, s46, 4096
    s_addc_u32 s47, s47, 0
    global_load_lds_dwordx4 v12, s[46:47] offset:0 nt
    global_load_lds_dwordx4 v13, s[46:47] offset:1024 nt
    global_load_lds_dwordx4 v14, s[46:47] offset:2048 nt
    global_load_lds_dwordx4 v15, s[46:47] offset:3072 nt
    s_add_u32 m0, s59, 12288
    s_add_u32 s46, s46, 4096
    s_addc_u32 s47, s47, 0
    global_load_lds_dwordx4 v12, s[46:47] offset:0 nt
    global_load_lds_dwordx4 v13, s[46:47] offset:1024 nt
    global_load_lds_dwordx4 v14, s[46:47] offset:2048 nt
    global_load_lds_dwordx4 v15, s[46:47] offset:3072 nt
L_k_issued:
    s_cmp_lt_u32 s60, 0
    s_cbranch_scc1 L_kpass
    s_add_u32 s56, s60, 1
    v_mov_b32 v114, s56
    s_mov_b64 exec, 1
    ds_max_u32 v112, v114 offset:4
    s_mov_b64 exec, -1
L_kpass:
    s_cmp_eq_u32 s11, 0
    s_cbranch_scc1 L_k_done
    v_lshl_add_u32 v12, v2, 8, v4
    v_add_u32 v12, s59, v12
    v_xor_b32 v13, 64, v12
    v_xor_b32 v14, 128, v12
    v_xor_b32 v15, 192, v12
    v_and_b32 v6, 1, v1
    v_lshlrev_b32 v4, 8, v6
    v_lshl_add_u32 v4, v3, 4, v4
    v_add_u32 v4, 157440, v4
    v_lshlrev_b32 v5, 2, v6
    v_add_u32 v5, 157952, v5
    v_mov_b32 v8, 146720
    v_mov_b32 v9, 1
    v_mov_b32 v24, 0xff000000
    v_mov_b32 v25, 0xff000000
    v_mov_b32 v26, 0xff000000
    v_mov_b32 v27, 0xff000000
    v_mov_b32 v28, 0xff000000
    v_mov_b32 v29, 0xff000000
    v_mov_b32 v30, 0xff000000
    v_mov_b32 v31, 0xff000000
    s_add_u32 s57, s9, 1
    s_lshr_b32 s57, s57, 1
    s_lshl_b32 s15, s63, 4
    s_add_u32 s15, s15, 146432
    v_lshl_add_u32 v10, v6, 7, s15
    v_lshl_add_u32 v10, v3, 2, v10
    s_lshl_b32 s15, s63, 8
    s_add_u32 s15, s15, 148736
    v_lshl_add_u32 v11, v6, 6, s15
    v_lshl_add_u32 v11, v3, 4, v11
    v_and_b32 v7, 8, v2
    v_lshl_add_u32 v11, v7, 4, v11
    v_and_b32 v7, 6, v2
    v_lshl_add_u32 v11, v7, 1, v11
    s_mov_b32 s60, 0xcccccccc
    s_mov_b32 s61, 0xcccccccc
    s_mov_b32 s14, 0x3db504f3
    s_mov_b32 s15, 0x3fb8aa3b
    s_waitcnt lgkmcnt(0)
    s_mul_i32 s10, s55, 1664525
    s_add_u32 s10, s10, 1013904223
    s_max_u32 s10, s10, 1
    s_waitcnt vmcnt(0)
    ds_read_b128 v[32:35], v12 offset:0
    ds_read_b128 v[36:39], v13 offset:0
    ds_read_b128 v[40:43], v14 offset:0
    ds_read_b128 v[44:47], v15 offset:0
    ds_read_b128 v[48:51], v12 offset:4096
    ds_read_b128 v[52:55], v13 offset:4096
    ds_read_b128 v[56:59], v14 offset:4096
    ds_read_b128 v[60:63], v15 offset:4096
    ds_read_b128 v[64:67], v12 offset:8192
    ds_read_b128 v[68:71], v13 offset:8192
    ds_read_b128 v[72:75], v14 offset:8192
    ds_read_b128 v[76:79], v15 offset:8192
    ds_read_b128 v[80:83], v12 offset:12288
    ds_read_b128 v[84:87], v13 offset:12288
    ds_read_b128 v[88:91], v14 offset:12288
    ds_read_b128 v[92:95], v15 offset:12288
L_spin_q:
    ds_read_b32 v7, v8
    s_waitcnt lgkmcnt(0)
    v_cmp_ne_u32 vcc, 1, v7
    s_cbranch_vccz L_spin_q_ok
    s_sleep 1
    s_sub_u32 s13, s13, 1
    s_cbranch_scc0 L_spin_q
    s_branch L_end
L_spin_q_ok:
    ds_read_b128 v[96:99], v4 offset:0
    ds_read_b128 v[100:103], v4 offset:64
    ds_read_b128 v[104:107], v4 offset:128
    ds_read_b128 v[108:111], v4 offset:192
    v_mov_b32 v8, 146704
    s_waitcnt lgkmcnt(3)
    v_mfma_f32_16x16x32_bf16 v[16:19], v[32:35], v[96:99], 0
    v_mfma_f32_16x16x32_bf16 v[20:23], v[48:51], v[96:99], 0
    s_waitcnt lgkmcnt(2)
    v_mfma_f32_16x16x32_bf16 v[16:19], v[36:39], v[100:103], v[16:19]
    v_mfma_f32_16x16x32_bf16 v[20:23], v[52:55], v[100:103], v[20:23]
    s_waitcnt lgkmcnt(1)
    v_mfma_f32_16x16x32_bf16 v[16:19], v[40:43], v[104:107], v[16:19]
    v_mfma_f32_16x16x32_bf16 v[20:23], v[56:59], v[104:107], v[20:23]
    s_waitcnt lgkmcnt(0)
    v_mfma_f32_16x16x32_bf16 v[16:19], v[44:47], v[108:111], v[16:19]
    v_mfma_f32_16x16x32_bf16 v[20:23], v[60:63], v[108:111], v[20:23]
    s_cmp_lt_u32 s11, 2
    s_cbranch_scc1 L_k_mm
    v_mfma_f32_16x16x32_bf16 v[24:27], v[64:67], v[96:99], 0
    v_mfma_f32_16x16x32_bf16 v[28:31], v[80:83], v[96:99], 0
    v_mfma_f32_16x16x32_bf16 v[24:27], v[68:71], v[100:103], v[24:27]
    v_mfma_f32_16x16x32_bf16 v[28:31], v[84:87], v[100:103], v[28:31]
    v_mfma_f32_16x16x32_bf16 v[24:27], v[72:75], v[104:107], v[24:27]
    v_mfma_f32_16x16x32_bf16 v[28:31], v[88:91], v[104:107], v[28:31]
    v_mfma_f32_16x16x32_bf16 v[24:27], v[76:79], v[108:111], v[24:27]
    v_mfma_f32_16x16x32_bf16 v[28:31], v[92:95], v[108:111], v[28:31]
L_k_mm:
    s_nop 5
    v_mov_b32_dpp v16, v20 quad_perm:[0,1,2,3] row_mask:0xf bank_mask:0x2
    v_mov_b32_dpp v17, v21 quad_perm:[0,1,2,3] row_mask:0xf bank_mask:0x2
    v_mov_b32_dpp v18, v22 quad_perm:[0,1,2,3] row_mask:0xf bank_mask:0x2
    v_mov_b32_dpp v19, v23 quad_perm:[0,1,2,3] row_mask:0xf bank_mask:0x2
    v_mov_b32_dpp v16, v24 quad_perm:[0,1,2,3] row_mask:0xf bank_mask:0x4
    v_mov_b32_dpp v17, v25 quad_perm:[0,1,2,3] row_mask:0xf bank_mask:0x4
    v_mov_b32_dpp v18, v26 quad_perm:[0,1,2,3] row_mask:0xf bank_mask:0x4
    v_mov_b32_dpp v19, v27 quad_perm:[0,1,2,3] row_mask:0xf bank_mask:0x4
    v_mov_b32_dpp v16, v28 quad_perm:[0,1,2,3] row_mask:0xf bank_mask:0x8
    v_mov_b32_dpp v17, v29 quad_perm:[0,1,2,3] row_mask:0xf bank_mask:0x8
    v_mov_b32_dpp v18, v30 quad_perm:[0,1,2,3] row_mask:0xf bank_mask:0x8
    v_mov_b32_dpp v19, v31 quad_perm:[0,1,2,3] row_mask:0xf bank_mask:0x8
    v_cndmask_b32 v16, v16, v18, s[60:61]
    v_cndmask_b32 v17, v17, v19, s[60:61]
    v_cvt_pk_bf16_f32 v18, v16, v17
    v_lshlrev_b32 v16, 16, v18
    v_and_b32 v17, s54, v18
    v_mul_f32 v16, s14, v16
    v_mul_f32 v17, s14, v17
    v_cvt_pk_bf16_f32 v18, v16, v17
    v_lshlrev_b32 v16, 16, v18
    v_and_b32 v17, s54, v18
    v_max_f32 v7, v16, v17
    s_nop 1
    v_max_f32_dpp v7, v7, v7 row_ror:8 row_mask:0xf bank_mask:0xf
    s_nop 1
    v_max_f32_dpp v7, v7, v7 row_ror:4 row_mask:0xf bank_mask:0xf
    s_nop 1
    v_max_f32_dpp v7, v7, v7 row_ror:2 row_mask:0xf bank_mask:0xf
    s_mov_b32 exec_lo, 0x00030003
    s_mov_b32 exec_hi, 0x00030003
    ds_max_f32 v5, v7
    s_mov_b64 exec, 1
    ds_add_u32 v8, v9
    s_mov_b64 exec, -1
L_spin_mx:
    ds_read_b32 v18, v8
    ds_read_b32 v7, v5
    s_waitcnt lgkmcnt(0)
    v_cmp_ne_u32 vcc, s57, v18
    s_cbranch_vccz L_spin_mx_ok
    s_sub_u32 s13, s13, 1
    s_cbranch_scc0 L_spin_mx
    s_branch L_end
L_spin_mx_ok:
    v_mul_f32 v7, s15, v7
    v_fma_f32 v16, v16, s15, -v7
    v_fma_f32 v17, v17, s15, -v7
    v_exp_f32 v16, v16
    v_exp_f32 v17, v17
    s_nop 0
    v_cvt_pk_bf16_f32 v18, v16, v17
    v_add_f32 v7, v16, v17
    ds_write_b32 v11, v18
    s_nop 0
    v_add_f32_dpp v7, v7, v7 row_ror:8 row_mask:0xf bank_mask:0xf
    s_nop 1
    v_add_f32_dpp v7, v7, v7 row_ror:4 row_mask:0xf bank_mask:0xf
    s_nop 1
    v_add_f32_dpp v7, v7, v7 row_ror:2 row_mask:0xf bank_mask:0xf
    s_mov_b32 exec_lo, 0x00030003
    s_mov_b32 exec_hi, 0x00030003
    ds_write_b32 v10, v7
    s_mov_b64 exec, 1
    ds_add_u32 v8, v9 offset:28
    s_mov_b64 exec, -1
L_k_done:
    s_branch L_after_bp
L_vwave:
    v_lshlrev_b32 v5, 10, v3
    v_lshl_add_u32 v5, v2, 4, v5
    s_add_u32 s58, s58, 4096
    v_mov_b32 v112, 146720
    s_lshl_b32 s14, s4, 2
    s_add_u32 s14, s14, s6
    s_lshl_b32 s14, s14, 10
    s_add_u32 s14, s14, 32768
    v_lshl_add_u32 v113, v1, 4, s14
    s_sub_u32 s60, s3, 2
    s_mov_b32 s61, 0
    s_waitcnt lgkmcnt(0)
    s_load_dword s55, s[44:45], 0
    s_add_u32 s64, s44, 524288
    s_addc_u32 s65, s45, 0
    s_add_u32 s46, s20, s58
    s_addc_u32 s47, s21, 0
    s_mov_b32 s52, 0x05040100
    s_mov_b32 s53, 0x07060302
    v_and_b32 v4, 1, v3
    v_lshlrev_b32 v4, 9, v4
    v_lshl_add_u32 v4, v2, 5, v4
    v_lshrrev_b32 v6, 1, v3
    v_lshl_add_u32 v4, v6, 4, v4
    s_lshl_b32 s15, s63, 10
    s_add_u32 s15, s15, 139264
    v_add_u32 v4, s15, v4
    s_lshl_b32 s15, s63, 8
    s_add_u32 s15, s15, 148736
    v_and_b32 v6, 4, v2
    v_lshl_add_u32 v6, v6, 4, s15
    v_lshl_add_u32 v6, v3, 4, v6
    s_barrier
    s_cmp_lt_u32 s60, 1
    s_cbranch_scc1 L_vtok_go
L_vtok:
    ds_read_b128 v[116:119], v112
    s_waitcnt lgkmcnt(0)
    v_cmp_ne_u32 vcc, s60, v117
    s_cbranch_vccz L_vtok_ok
    s_sleep 3
    s_sub_u32 s13, s13, 1
    s_cbranch_scc0 L_vtok
    s_branch L_end
L_vtok_ok:
    v_readfirstlane_b32 s61, v116
    s_nop 0
    s_xor_b32 s61, s61, 1
    s_cmp_ge_u32 s60, 4
    s_cselect_b32 s61, s61, 0
L_vtok_go:
    s_cmp_eq_u32 s11, 0
    s_cbranch_scc1 L_v_none
    s_cmp_eq_u32 s61, 0
    s_cbranch_scc1 L_vp0
    s_mov_b32 m0, 147456
    s_nop 0
    global_load_lds_dwordx4 v113, s[64:65] sc1
L_vp0:
    global_load_dwordx4 v[32:35], v5, s[46:47] offset:-4096 nt
    global_load_dwordx4 v[36:39], v5, s[46:47] offset:-3840 nt
    global_load_dwordx4 v[40:43], v5, s[46:47] offset:-3584 nt
    global_load_dwordx4 v[44:47], v5, s[46:47] offset:-3328 nt
    global_load_dwordx4 v[48:51], v5, s[46:47] offset:0 nt
    global_load_dwordx4 v[52:55], v5, s[46:47] offset:256 nt
    global_load_dwordx4 v[56:59], v5, s[46:47] offset:512 nt
    global_load_dwordx4 v[60:63], v5, s[46:47] offset:768 nt
    s_mov_b32 s69, s58
    s_mov_b32 s58, 0
    s_mov_b32 s59, -1
    v_mov_b32 v22, 1
    s_cmp_lt_u32 s11, 2
    s_cbranch_scc1 L_v_one
    v_add_u32 v5, 8192, v5
    s_cmp_eq_u32 s61, 0
    s_cbranch_scc1 L_vp1
    s_mov_b32 m0, 147456
    s_nop 0
    global_load_lds_dwordx4 v113, s[64:65] sc1
L_vp1:
    global_load_dwordx4 v[64:67], v5, s[46:47] offset:-4096 nt
    global_load_dwordx4 v[68:71], v5, s[46:47] offset:-3840 nt
    global_load_dwordx4 v[72:75], v5, s[46:47] offset:-3584 nt
    global_load_dwordx4 v[76:79], v5, s[46:47] offset:-3328 nt
    global_load_dwordx4 v[80:83], v5, s[46:47] offset:0 nt
    global_load_dwordx4 v[84:87], v5, s[46:47] offset:256 nt
    global_load_dwordx4 v[88:91], v5, s[46:47] offset:512 nt
    global_load_dwordx4 v[92:95], v5, s[46:47] offset:768 nt
    s_cmp_lt_u32 s60, 0
    s_cbranch_scc1 L_vpass2
    s_add_u32 s56, s60, 1
    v_mov_b32 v114, s56
    s_mov_b64 exec, 1
    ds_max_u32 v112, v114 offset:4
    s_mov_b64 exec, -1
L_vpass2:
    s_setprio 2
    s_waitcnt vmcnt(14)
    v_perm_b32 v96, v36, v32, s52
    v_perm_b32 v100, v36, v32, s53
    v_perm_b32 v104, v37, v33, s52
    v_perm_b32 v108, v37, v33, s53
    v_perm_b32 v112, v38, v34, s52
    v_perm_b32 v116, v38, v34, s53
    v_perm_b32 v120, v39, v35, s52
    v_perm_b32 v124, v39, v35, s53
    s_waitcnt vmcnt(12)
    v_perm_b32 v97, v44, v40, s52
    v_perm_b32 v101, v44, v40, s53
    v_perm_b32 v105, v45, v41, s52
    v_perm_b32 v109, v45, v41, s53
    v_perm_b32 v113, v46, v42, s52
    v_perm_b32 v117, v46, v42, s53
    v_perm_b32 v121, v47, v43, s52
    v_perm_b32 v125, v47, v43, s53
    s_waitcnt vmcnt(10)
    v_perm_b32 v98, v52, v48, s52
    v_perm_b32 v102, v52, v48, s53
    v_perm_b32 v106, v53, v49, s52
    v_perm_b32 v110, v53, v49, s53
    v_perm_b32 v114, v54, v50, s52
    v_perm_b32 v118, v54, v50, s53
    v_perm_b32 v122, v55, v51, s52
    v_perm_b32 v126, v55, v51, s53
    s_waitcnt vmcnt(8)
    v_perm_b32 v99, v60, v56, s52
    v_perm_b32 v103, v60, v56, s53
    v_perm_b32 v107, v61, v57, s52
    v_perm_b32 v111, v61, v57, s53
    v_perm_b32 v115, v62, v58, s52
    v_perm_b32 v119, v62, v58, s53
    v_perm_b32 v123, v63, v59, s52
    v_perm_b32 v127, v63, v59, s53
    s_add_u32 s56, s9, 3
    s_lshr_b32 s56, s56, 1
    v_mov_b32 v20, 146732
L_vw2:
    ds_read_b32 v21, v20
    s_waitcnt lgkmcnt(0)
    v_cmp_gt_u32 vcc, s56, v21
    s_cbranch_vccz L_vw2_ok
    s_sleep 1
    s_sub_u32 s13, s13, 1
    s_cbranch_scc0 L_vw2
    s_branch L_end
L_vw2_ok:
    ds_read_b128 v[8:11], v6
    ds_read_b128 v[12:15], v6 offset:128
    s_waitcnt lgkmcnt(0)
    v_mfma_f32_16x16x32_bf16 v[32:35], v[8:11], v[96:99], 0
    v_mfma_f32_16x16x32_bf16 v[36:39], v[8:11], v[100:103], 0
    v_mfma_f32_16x16x32_bf16 v[40:43], v[8:11], v[104:107], 0
    v_mfma_f32_16x16x32_bf16 v[44:47], v[8:11], v[108:111], 0
    v_mfma_f32_16x16x32_bf16 v[48:51], v[8:11], v[112:115], 0
    v_mfma_f32_16x16x32_bf16 v[52:55], v[8:11], v[116:119], 0
    v_mfma_f32_16x16x32_bf16 v[56:59], v[8:11], v[120:123], 0
    v_mfma_f32_16x16x32_bf16 v[60:63], v[8:11], v[124:127], 0
    s_waitcnt vmcnt(6)
    v_perm_b32 v96, v68, v64, s52
    v_perm_b32 v100, v68, v64, s53
    v_perm_b32 v104, v69, v65, s52
    v_perm_b32 v108, v69, v65, s53
    v_perm_b32 v112, v70, v66, s52
    v_perm_b32 v116, v70, v66, s53
    v_perm_b32 v120, v71, v67, s52
    v_perm_b32 v124, v71, v67, s53
    s_waitcnt vmcnt(4)
    v_perm_b32 v97, v76, v72, s52
    v_perm_b32 v101, v76, v72, s53
    v_perm_b32 v105, v77, v73, s52
    v_perm_b32 v109, v77, v73, s53
    v_perm_b32 v113, v78, v74, s52
    v_perm_b32 v117, v78, v74, s53
    v_perm_b32 v121, v79, v75, s52
    v_perm_b32 v125, v79, v75, s53
    s_waitcnt vmcnt(2)
    v_perm_b32 v98, v84, v80, s52
    v_perm_b32 v102, v84, v80, s53
    v_perm_b32 v106, v85, v81, s52
    v_perm_b32 v110, v85, v81, s53
    v_perm_b32 v114, v86, v82, s52
    v_perm_b32 v118, v86, v82, s53
    v_perm_b32 v122, v87, v83, s52
    v_perm_b32 v126, v87, v83, s53
    s_waitcnt vmcnt(0)
    v_perm_b32 v99, v92, v88, s52
    v_perm_b32 v103, v92, v88, s53
    v_perm_b32 v107, v93, v89, s52
    v_perm_b32 v111, v93, v89, s53
    v_perm_b32 v115, v94, v90, s52
    v_perm_b32 v119, v94, v90, s53
    v_perm_b32 v123, v95, v91, s52
    v_perm_b32 v127, v95, v91, s53
    v_mfma_f32_16x16x32_bf16 v[32:35], v[12:15], v[96:99], v[32:35]
    v_mfma_f32_16x16x32_bf16 v[36:39], v[12:15], v[100:103], v[36:39]
    v_mfma_f32_16x16x32_bf16 v[40:43], v[12:15], v[104:107], v[40:43]
    v_mfma_f32_16x16x32_bf16 v[44:47], v[12:15], v[108:111], v[44:47]
    v_mfma_f32_16x16x32_bf16 v[48:51], v[12:15], v[112:115], v[48:51]
    v_mfma_f32_16x16x32_bf16 v[52:55], v[12:15], v[116:119], v[52:55]
    v_mfma_f32_16x16x32_bf16 v[56:59], v[12:15], v[120:123], v[56:59]
    v_mfma_f32_16x16x32_bf16 v[60:63], v[12:15], v[124:127], v[60:63]
    s_branch L_v_out
L_v_one:
    s_mov_b32 s58, s69
    s_sub_u32 s56, s58, 0x10000
    s_and_b32 s56, s56, 0xffe00000
    s_mov_b32 s57, s7
    s_add_u32 s57, s57, 1
    s_cmp_eq_u32 s57, 5
    s_cselect_b32 s57, 0, s57
    s_min_u32 s59, s57, 3
    s_add_u32 s59, s59, 252
    s_lshl_b32 s59, s59, 13
    s_add_u32 s59, s59, s56
    v_lshl_add_u32 v23, v1, 7, s59
    global_load_dword v24, v23, s[20:21]
    s_mov_b32 s58, 0
    s_mov_b32 s59, -1
    s_cmp_lt_u32 s60, 0
    s_cbranch_scc1 L_vpass1
    s_add_u32 s56, s60, 1
    v_mov_b32 v114, s56
    s_mov_b64 exec, 1
    ds_max_u32 v112, v114 offset:4
    s_mov_b64 exec, -1
L_vpass1:
    s_setprio 2
    s_add_u32 s56, s9, 3
    s_lshr_b32 s56, s56, 1
    v_mov_b32 v20, 146732
L_vw1:
    ds_read_b32 v21, v20
    s_waitcnt lgkmcnt(0)
    v_cmp_gt_u32 vcc, s56, v21
    s_cbranch_vccz L_vw1_ok
    s_sleep 1
    s_sub_u32 s13, s13, 1
    s_cbranch_scc0 L_vw1
    s_branch L_end
L_vw1_ok:
    ds_read_b128 v[8:11], v6
    s_waitcnt vmcnt(7)
    v_perm_b32 v96, v36, v32, s52
    v_perm_b32 v100, v36, v32, s53
    v_perm_b32 v104, v37, v33, s52
    v_perm_b32 v108, v37, v33, s53
    v_perm_b32 v112, v38, v34, s52
    v_perm_b32 v116, v38, v34, s53
    v_perm_b32 v120, v39, v35, s52
    v_perm_b32 v124, v39, v35, s53
    s_waitcnt vmcnt(5)
    v_perm_b32 v97, v44, v40, s52
    v_perm_b32 v101, v44, v40, s53
    v_perm_b32 v105, v45, v41, s52
    v_perm_b32 v109, v45, v41, s53
    v_perm_b32 v113, v46, v42, s52
    v_perm_b32 v117, v46, v42, s53
    v_perm_b32 v121, v47, v43, s52
    v_perm_b32 v125, v47, v43, s53
    s_waitcnt vmcnt(3)
    v_perm_b32 v98, v52, v48, s52
    v_perm_b32 v102, v52, v48, s53
    v_perm_b32 v106, v53, v49, s52
    v_perm_b32 v110, v53, v49, s53
    v_perm_b32 v114, v54, v50, s52
    v_perm_b32 v118, v54, v50, s53
    v_perm_b32 v122, v55, v51, s52
    v_perm_b32 v126, v55, v51, s53
    s_waitcnt vmcnt(1)
    v_perm_b32 v99, v60, v56, s52
    v_perm_b32 v103, v60, v56, s53
    v_perm_b32 v107, v61, v57, s52
    v_perm_b32 v111, v61, v57, s53
    v_perm_b32 v115, v62, v58, s52
    v_perm_b32 v119, v62, v58, s53
    v_perm_b32 v123, v63, v59, s52
    v_perm_b32 v127, v63, v59, s53
    s_waitcnt lgkmcnt(0)
    v_mfma_f32_16x16x32_bf16 v[32:35], v[8:11], v[96:99], 0
    v_mfma_f32_16x16x32_bf16 v[36:39], v[8:11], v[100:103], 0
    v_mfma_f32_16x16x32_bf16 v[40:43], v[8:11], v[104:107], 0
    v_mfma_f32_16x16x32_bf16 v[44:47], v[8:11], v[108:111], 0
    v_mfma_f32_16x16x32_bf16 v[48:51], v[8:11], v[112:115], 0
    v_mfma_f32_16x16x32_bf16 v[52:55], v[8:11], v[116:119], 0
    v_mfma_f32_16x16x32_bf16 v[56:59], v[8:11], v[120:123], 0
    v_mfma_f32_16x16x32_bf16 v[60:63], v[8:11], v[124:127], 0
L_v_out:
    s_nop 4
    v_cndmask_b32 v16, v32, v48, s[58:59]
    v_cndmask_b32 v17, v36, v52, s[58:59]
    v_cndmask_b32 v18, v40, v56, s[58:59]
    v_cndmask_b32 v19, v44, v60, s[58:59]
    ds_write_b128 v4, v[16:19]
    s_mov_b64 exec, 1
    ds_add_u32 v20, v22 offset:4
    s_mov_b64 exec, -1
    s_setprio 0
    s_waitcnt lgkmcnt(0)
    s_cmp_ge_u32 s5, 18
    s_cbranch_scc1 L_end
    s_cmp_eq_u32 s3, 9
    s_cbranch_scc1 L_mlp_gelu
    s_cmp_eq_u32 s3, 10
    s_cbranch_scc1 L_mlp_fin
    s_branch L_end
L_v_none:
    s_sub_u32 s56, s58, 0x10000
    s_and_b32 s56, s56, 0xffe00000
    s_mov_b32 s57, s7
    s_add_u32 s57, s57, 1
    s_cmp_eq_u32 s57, 5
    s_cselect_b32 s57, 0, s57
    s_min_u32 s59, s57, 3
    s_add_u32 s59, s59, 252
    s_lshl_b32 s59, s59, 13
    s_add_u32 s59, s59, s56
    v_lshl_add_u32 v23, v1, 7, s59
    global_load_dword v24, v23, s[20:21]
    s_cmp_lt_u32 s60, 0
    s_cbranch_scc1 L_vpass0
    s_add_u32 s56, s60, 1
    v_mov_b32 v114, s56
    s_mov_b64 exec, 1
    ds_max_u32 v112, v114 offset:4
    s_mov_b64 exec, -1
L_vpass0:
    s_waitcnt lgkmcnt(0)
    s_branch L_end
L_att_special:
    s_setprio 0
    v_mov_b32 v8, 0
    v_mov_b32 v9, 0
    v_mov_b32 v10, 0
    v_mov_b32 v11, 0
    v_lshlrev_b32 v4, 4, v1
    v_add_u32 v4, 145408, v4
    ds_write_b128 v4, v[8:11]
    ds_write_b128 v4, v[8:11] offset:1024
    ds_write_b128 v4, v[8:11] offset:2048
    v_mov_b32 v8, 0xff7fffff
    v_mov_b32 v9, 0xff7fffff
    v_mov_b32 v4, 157952
    ds_write_b64 v4, v[8:9]
    s_waitcnt lgkmcnt(0)
    s_barrier
    s_cmp_eq_u32 s3, 0
    s_cbranch_scc1 L_qpoll
    s_cmp_ge_u32 s5, 18
    s_cbranch_scc1 L_pf2
    v_mov_b32 v8, -1
    v_mov_b32 v9, -1
    v_mov_b32 v10, -1
    v_mov_b32 v11, -1
    s_mul_i32 s14, s12, 4736
    s_add_u32 s14, s14, 1049600
    v_lshl_add_u32 v4, v1, 4, s14
    global_store_dwordx4 v4, v[8:11], s[44:45] offset:-1024 sc1
    global_store_dwordx4 v4, v[8:11], s[44:45] offset:0 sc1
    global_store_dwordx4 v4, v[8:11], s[44:45] offset:1024 sc1
    global_store_dwordx4 v4, v[8:11], s[44:45] offset:2048 sc1
    s_mov_b32 exec_hi, 0
    global_store_dwordx4 v4, v[8:11], s[44:45] offset:3072 sc1
    s_mov_b64 exec, -1
L_pf2:
    s_waitcnt vmcnt(0)
    v_mov_b32 v4, 146732
    v_mov_b32 v5, 1
    s_mov_b64 exec, 1
    ds_add_u32 v4, v5
    s_mov_b64 exec, -1
    s_branch L_after_bp
L_qpoll:
    s_waitcnt lgkmcnt(0)
    s_mul_i32 s10, s55, 1664525
    s_add_u32 s10, s10, 1013904223
    s_max_u32 s10, s10, 1
    v_mov_b32 v112, 146720
    s_lshl_b32 s14, s4, 2
    s_add_u32 s14, s14, s6
    s_lshl_b32 s14, s14, 10
    s_add_u32 s14, s14, 32768
    v_lshl_add_u32 v113, v1, 4, s14
    s_sub_u32 s60, s3, 2
    s_mov_b32 s61, 0
    v_lshlrev_b32 v5, 3, v1
    v_add_u32 v5, 157440, v5
    v_lshlrev_b32 v4, 4, v1
    v_add_u32 v4, 147456, v4
    v_mov_b32 v28, 146720
    v_mov_b32 v29, 1
    s_mov_b32 s56, 14
    s_mov_b32 s57, 24
    s_add_u32 s64, s44, 524288
    s_addc_u32 s65, s45, 0
    s_mov_b32 m0, 147456
L_poll_q:
    ds_read_b128 v[8:11], v4
    ds_read_b32 v12, v28 offset:4
    s_waitcnt lgkmcnt(0)
    v_xor_b32 v6, s10, v9
    v_xor_b32 v7, s10, v11
    v_or_b32 v6, v6, v7
    v_cmp_ne_u32 vcc, 0, v6
    s_cbranch_vccz L_q_got
    v_cmp_ne_u32 vcc, s56, v12
    s_cbranch_vccnz L_q_wait
    s_sub_u32 s57, s57, 1
    s_cbranch_scc1 L_q_glob
    global_load_lds_dwordx4 v113, s[64:65] sc1
    s_sleep 4
    s_branch L_q_wait
L_q_glob:
    s_mov_b32 s57, 0
    s_waitcnt vmcnt(0)
    global_load_lds_dwordx4 v113, s[44:45] sc1
    s_waitcnt vmcnt(0)
L_q_wait:
    s_sub_u32 s13, s13, 1
    s_cbranch_scc0 L_poll_q
    s_branch L_end
L_q_got:
    ds_read_b128 v[8:11], v4
    s_waitcnt lgkmcnt(0)
    v_xor_b32 v6, s10, v9
    v_xor_b32 v7, s10, v11
    v_or_b32 v6, v6, v7
    v_cmp_ne_u32 vcc, 0, v6
    s_cbranch_vccnz L_q_wait
    v_mov_b32 v9, v10
    ds_write_b64 v5, v[8:9]
    ds_write_b32 v28, v29
L_after_bp:
    s_mov_b32 s68, s3
    s_cmp_lt_u32 s3, 2
    s_cbranch_scc1 L_setup
    s_cmp_lt_u32 s5, 18
    s_cbranch_scc1 L_setup
    s_cmp_lt_u32 s3, 5
    s_cbranch_scc1 L_ln
    s_branch L_end
L_setup:
    s_sub_u32 s8, 8, s68
    s_bitcmp1_b32 s12, 0
    s_cselect_b32 s8, s8, s68
    s_lshl_b32 s56, s8, 12
    s_mul_i32 s14, s12, 36864
    s_lshl_b32 s15, s8, 7
    s_add_u32 s14, s14, s15
    s_add_u32 s48, s32, s14
    s_addc_u32 s49, s33, 0
    v_lshrrev_b32 v4, 3, v1
    v_mul_u32_u24 v4, 1152, v4
    v_and_b32 v7, 7, v1
    v_lshl_add_u32 v4, v7, 4, v4
    s_add_u32 s57, s56, 36864
    s_add_u32 s58, s57, 0
    v_mov_b32 v126, v4
    s_lshl_b32 s14, s12, 6
    s_mul_i32 s15, s8, 589824
    s_add_u32 s14, s14, s15
    s_add_u32 s46, s28, s14
    s_addc_u32 s47, s29, 0
    v_lshrrev_b32 v127, 2, v1
    v_mul_u32_u24 v127, 9216, v127
    v_and_b32 v7, 3, v1
    v_lshl_add_u32 v127, v7, 4, v127
    v_bfe_u32 v7, v1, 2, 2
    v_lshl_add_u32 v5, v3, 3, v7
    v_lshlrev_b32 v5, 6, v5
    v_and_b32 v7, 3, v1
    v_lshl_add_u32 v5, v7, 3, v5
    v_add_u32 v5, s56, v5
    v_bfe_u32 v7, v1, 2, 2
    v_lshl_add_u32 v9, v3, 3, v7
    v_lshlrev_b32 v9, 7, v9
    v_and_b32 v7, 3, v1
    v_lshl_add_u32 v9, v7, 3, v9
    v_add_u32 v9, s57, v9
    v_and_b32 v7, 1, v1
    v_mul_u32_u24 v6, 1152, v7
    v_lshl_add_u32 v6, v3, 4, v6
    s_lshl_b32 s14, s8, 7
    s_add_u32 s14, s14, 150528
    v_add_u32 v6, s14, v6
    s_mul_i32 s14, s4, 2304
    s_add_u32 s14, s14, 242688
    v_add_u32 v6, s14, v6
    v_and_b32 v7, 2, v1
    v_lshl_add_u32 v6, v7, 5, v6
    s_add_u32 s64, s44, 524288
    s_addc_u32 s65, s45, 0
    s_mul_i32 s14, s8, 256
    s_add_u32 s14, s14, 152832
    v_mul_u32_u24 v8, 128, v2
    v_lshl_add_u32 v8, v3, 4, v8
    v_add_u32 v8, s14, v8
    v_and_b32 v7, 1, v1
    v_lshlrev_b32 v7, 6, v7
    v_lshl_add_u32 v7, v3, 4, v7
    v_add_u32 v7, 157968, v7
    v_lshrrev_b32 v4, 1, v2
    v_mov_b32 v14, 146688
    v_cmp_eq_u32 vcc, 0, v4
    s_nop 1
    v_cndmask_b32 v10, v14, v7, vcc
    v_cmp_eq_u32 vcc, 1, v4
    s_nop 1
    v_cndmask_b32 v11, v14, v7, vcc
    v_cmp_eq_u32 vcc, 2, v4
    s_nop 1
    v_cndmask_b32 v12, v14, v7, vcc
    v_cmp_eq_u32 vcc, 3, v4
    s_nop 1
    v_cndmask_b32 v13, v14, v7, vcc
    v_and_b32 v7, 1, v1
    v_mul_u32_u24 v14, 2304, v7
    v_lshl_add_u32 v14, v4, 6, v14
    v_lshl_add_u32 v14, v3, 4, v14
    s_mul_i32 s14, s12, 4736
    s_lshl_b32 s15, s8, 8
    s_add_u32 s14, s14, s15
    s_add_u32 s14, s14, 1048576
    v_add_u32 v14, s14, v14
    s_cmp_ge_u32 s3, 2
    s_cbranch_scc1 L_bpub
L_red:
    s_add_u32 s58, s9, 3
    s_lshr_b32 s58, s58, 1
    v_mov_b32 v86, 146732
L_rw1:
    ds_read_b32 v87, v86
    s_waitcnt lgkmcnt(0)
    v_cmp_gt_u32 vcc, s58, v87
    s_cbranch_vccz L_rw1_ok
    s_sleep 2
    s_sub_u32 s13, s13, 1
    s_cbranch_scc0 L_rw1
    s_branch L_end
L_rw1_ok:
    s_add_u32 s64, s44, 524288
    s_addc_u32 s65, s45, 0
    s_lshl_b32 s15, s3, 7
    s_add_u32 s15, s15, 146432
    v_and_b32 v80, 31, v1
    v_lshl_add_u32 v80, v80, 2, s15
    ds_read_b32 v83, v80
    s_lshl_b32 s15, s3, 2
    s_add_u32 s15, s15, 157952
    v_mov_b32 v80, s15
    ds_read_b32 v82, v80
    s_lshl_b32 s15, s3, 9
    s_add_u32 s15, s15, 139264
    v_lshl_add_u32 v80, v1, 3, s15
    s_lshl_b32 s15, s4, 2
    s_add_u32 s15, s15, s6
    s_lshl_b32 s15, s15, 3
    s_add_u32 s15, s15, s7
    s_mul_i32 s15, s15, 640
    s_add_u32 s15, s15, 131072
    s_lshl_b32 s59, s3, 3
    s_add_u32 s59, s59, s15
    v_mov_b32 v84, s59
    s_lshl_b32 s14, s3, 8
    s_add_u32 s15, s15, s14
    v_lshl_add_u32 v81, v1, 2, s15
    s_waitcnt lgkmcnt(0)
    v_add_f32_dpp v83, v83, v83 row_ror:8 row_mask:0xf bank_mask:0xf
    s_nop 1
    v_add_f32_dpp v83, v83, v83 row_ror:4 row_mask:0xf bank_mask:0xf
    s_nop 1
    v_add_f32_dpp v83, v83, v83 row_ror:2 row_mask:0xf bank_mask:0xf
    s_nop 1
    v_add_f32_dpp v83, v83, v83 row_ror:1 row_mask:0xf bank_mask:0xf
    v_mov_b32 v85, v83
    s_nop 1
    v_permlane16_swap_b32 v83, v85
    v_add_f32 v83, v83, v85
    v_rcp_f32 v85, v83
    v_min_u32 v82, -2, v82
    v_min_u32 v83, -2, v83
    s_mov_b64 exec, 1
    global_store_dwordx2 v84, v[82:83], s[64:65] offset:512
    s_mov_b64 exec, -1
    s_setprio 3
    v_mov_b32 v102, 1
    s_add_u32 s58, s9, 1
    s_lshr_b32 s58, s58, 1
    v_mov_b32 v86, 146736
L_rw2:
    ds_read_b32 v87, v86
    s_waitcnt lgkmcnt(0)
    v_cmp_gt_u32 vcc, s58, v87
    s_cbranch_vccz L_rw2_ok
    s_sub_u32 s13, s13, 1
    s_cbranch_scc0 L_rw2
    s_branch L_end
L_rw2_ok:
    ds_read_b64 v[88:89], v80 offset:0
    ds_read_b64 v[90:91], v80 offset:1024
    ds_read_b64 v[92:93], v80 offset:2048
    ds_read_b64 v[94:95], v80 offset:3072
    ds_read_b64 v[96:97], v80 offset:4096
    ds_read_b64 v[98:99], v80 offset:5120
    ds_read_b64 v[100:101], v80 offset:6144
    s_waitcnt lgkmcnt(0)
    v_pk_add_f32 v[88:89], v[88:89], v[90:91]
    v_pk_add_f32 v[92:93], v[92:93], v[94:95]
    v_pk_add_f32 v[96:97], v[96:97], v[98:99]
    v_pk_add_f32 v[88:89], v[88:89], v[92:93]
    v_pk_add_f32 v[96:97], v[96:97], v[100:101]
    v_pk_add_f32 v[88:89], v[88:89], v[96:97]
    v_mul_f32 v88, v88, v85
    v_mul_f32 v89, v89, v85
    v_cvt_pk_bf16_f32 v88, v88, v89
    v_min_u32 v88, -2, v88
    global_store_dword v81, v88, s[64:65]
    global_store_dword v81, v88, s[44:45] sc1
    s_mov_b64 exec, 1
    global_store_dwordx2 v84, v[82:83], s[44:45] offset:512 sc1
    ds_add_u32 v86, v102 offset:4
    s_mov_b64 exec, -1
    s_setprio 0
    s_cmp_ge_u32 s5, 18
    s_cbranch_scc1 L_end
L_bpub:
    s_cmp_lt_u32 s68, 7
    s_cbranch_scc1 L_ew_late
    s_add_u32 s58, s9, 3
    s_lshr_b32 s58, s58, 1
    v_mov_b32 v86, 146732
L_ew_cp:
    ds_read_b32 v87, v86
    s_waitcnt lgkmcnt(0)
    v_cmp_gt_u32 vcc, s58, v87
    s_cbranch_vccz L_ew_cp_ok
    s_sleep 2
    s_sub_u32 s13, s13, 1
    s_cbranch_scc0 L_ew_cp
    s_branch L_end
L_ew_cp_ok:
    v_mov_b32 v86, 146724
L_ew_tk:
    ds_read_b32 v87, v86
    s_waitcnt lgkmcnt(0)
    v_cmp_gt_u32 vcc, 14, v87
    s_cbranch_vccz L_ew_tk_ok
    s_sleep 1
    s_sub_u32 s13, s13, 1
    s_cbranch_scc0 L_ew_tk
    s_branch L_end
L_ew_tk_ok:
    s_branch L_pw_ok
L_ew_late:
    v_mov_b32 v86, 146740
L_pw:
    ds_read_b32 v87, v86
    s_waitcnt lgkmcnt(0)
    v_cmp_gt_u32 vcc, 2, v87
    s_cbranch_vccz L_pw_ok
    s_sleep 1
    s_sub_u32 s13, s13, 1
    s_cbranch_scc0 L_pw
    s_branch L_end
L_pw_ok:
    s_mov_b32 m0, s57
    s_nop 0
    global_load_lds_dwordx4 v126, s[48:49] offset:0 nt
    v_add_u32 v126, 8192, v126
    global_load_lds_dwordx4 v126, s[48:49] offset:1024 nt
    v_add_u32 v126, 8192, v126
    global_load_lds_dwordx4 v126, s[48:49] offset:2048 nt
    v_add_u32 v126, 8192, v126
    global_load_lds_dwordx4 v126, s[48:49] offset:3072 nt
    v_mov_b32 v86, 146740
L_ca:
    ds_read_b32 v87, v86
    s_waitcnt lgkmcnt(0)
    v_cmp_gt_u32 vcc, 2, v87
    s_cbranch_vccz L_ca_ok
    s_sleep 1
    s_sub_u32 s13, s13, 1
    s_cbranch_scc0 L_ca
    s_branch L_end
L_ca_ok:
    s_mov_b32 m0, s56
    s_nop 0
    global_load_lds_dwordx4 v127, s[46:47] offset:0
    v_add_u32 v127, 146432, v127
    global_load_lds_dwordx4 v127, s[46:47] offset:1024
    v_add_u32 v127, 146432, v127
    global_load_lds_dwordx4 v127, s[46:47] offset:2048
    v_add_u32 v127, 146432, v127
    global_load_lds_dwordx4 v127, s[46:47] offset:3072
    s_waitcnt vmcnt(4)
    ds_read_b64_tr_b16 v[64:65], v9 offset:0
    ds_read_b64_tr_b16 v[66:67], v9 offset:512
    ds_read_b64_tr_b16 v[68:69], v9 offset:32
    ds_read_b64_tr_b16 v[70:71], v9 offset:544
    ds_read_b64_tr_b16 v[72:73], v9 offset:64
    ds_read_b64_tr_b16 v[74:75], v9 offset:576
    ds_read_b64_tr_b16 v[76:77], v9 offset:96
    ds_read_b64_tr_b16 v[78:79], v9 offset:608
    s_waitcnt vmcnt(0)
    ds_read_b64_tr_b16 v[24:25], v5 offset:0
    ds_read_b64_tr_b16 v[26:27], v5 offset:256
    ds_read_b64_tr_b16 v[28:29], v5 offset:32
    ds_read_b64_tr_b16 v[30:31], v5 offset:288
    ds_read_b64_tr_b16 v[32:33], v5 offset:2048
    ds_read_b64_tr_b16 v[34:35], v5 offset:2304
    ds_read_b64_tr_b16 v[36:37], v5 offset:2080
    ds_read_b64_tr_b16 v[38:39], v5 offset:2336
    s_or_b32 s13, s13, 63
    s_mov_b32 exec_lo, 0x000f000f
    s_mov_b32 exec_hi, 0x000f000f
L_poll_y:
    s_and_b32 s59, s13, 63
    s_cselect_b64 s[66:67], s[64:65], s[44:45]
    global_load_dwordx4 v[16:19], v6, s[66:67] sc1
    s_waitcnt vmcnt(0)
    v_max3_u32 v7, v16, v17, v18
    v_max_u32 v7, v7, v19
    v_cmp_eq_u32 vcc, -1, v7
    s_cbranch_vccz L_poll_y_ok
    s_sub_u32 s13, s13, 1
    s_cbranch_scc0 L_poll_y
    s_branch L_end
L_poll_y_ok:
    s_mov_b64 exec, -1
    v_mov_b32_dpp v20, v16 quad_perm:[2,3,2,3] row_mask:0xf bank_mask:0xf
    v_mov_b32_dpp v21, v17 quad_perm:[2,3,2,3] row_mask:0xf bank_mask:0xf
    v_mov_b32_dpp v22, v18 quad_perm:[2,3,2,3] row_mask:0xf bank_mask:0xf
    v_mov_b32_dpp v23, v19 quad_perm:[2,3,2,3] row_mask:0xf bank_mask:0xf
    s_waitcnt lgkmcnt(0)
    v_mfma_f32_16x16x32_bf16 v[56:59], v[24:27], v[16:19], 0
    v_mfma_f32_16x16x32_bf16 v[60:63], v[28:31], v[16:19], 0
    v_mfma_f32_16x16x32_bf16 v[56:59], v[32:35], v[20:23], v[56:59]
    v_mfma_f32_16x16x32_bf16 v[60:63], v[36:39], v[20:23], v[60:63]
    s_mov_b32 exec_lo, 0x00030003
    s_mov_b32 exec_hi, 0x00030003
    s_nop 4
    ds_write_b128 v8, v[56:59] offset:0
    ds_write_b128 v8, v[60:63] offset:64
    s_mov_b64 exec, -1
    s_waitcnt lgkmcnt(0)
    s_barrier
    s_barrier
    ds_read_b128 v[16:19], v10
    ds_read_b128 v[20:23], v11
    ds_read_b128 v[24:27], v12
    ds_read_b128 v[28:31], v13
    s_waitcnt lgkmcnt(3)
    v_mfma_f32_16x16x32_bf16 v[32:35], v[64:67], v[16:19], 0
    s_waitcnt lgkmcnt(2)
    v_mfma_f32_16x16x32_bf16 v[32:35], v[68:71], v[20:23], v[32:35]
    s_waitcnt lgkmcnt(1)
    v_mfma_f32_16x16x32_bf16 v[32:35], v[72:75], v[24:27], v[32:35]
    s_waitcnt lgkmcnt(0)
    v_mfma_f32_16x16x32_bf16 v[32:35], v[76:79], v[28:31], v[32:35]
    s_mov_b32 exec_lo, 0x00ff00ff
    s_mov_b32 exec_hi, 0x00ff00ff
    s_nop 5
    global_store_dwordx4 v14, v[32:35], s[44:45] sc1
    s_branch L_end
L_ln:
    v_and_b32 v80, 31, v1
    v_lshrrev_b32 v81, 5, v1
    s_sub_u32 s68, s3, 2
    s_lshl_b32 s69, s68, 5
    v_add_u32 v80, s69, v80
    v_mul_u32_u24 v83, 1152, v81
    v_lshl_add_u32 v82, v80, 3, v83
    v_lshl_add_u32 v83, v80, 2, v83
    global_load_dwordx2 v[84:85], v82, s[16:17]
    global_load_dword v86, v83, s[16:17] offset:768
    s_mul_i32 s58, s68, 4608
    s_add_u32 s58, s58, 114688
    v_and_b32 v7, 31, v1
    v_lshl_add_u32 v15, v7, 5, s58
    v_lshl_add_u32 v87, v7, 4, s58
    s_lshl_b32 s59, s68, 10
    s_add_u32 s59, s59, 13312
    v_lshl_add_u32 v52, v1, 4, s59
    s_lshl_b32 s59, s68, 9
    s_add_u32 s59, s59, 16384
    v_lshl_add_u32 v53, v1, 4, s59
    v_lshlrev_b32 v118, 1, v82
    v_lshlrev_b32 v119, 1, v83
    s_mul_i32 s59, s4, 2304
    s_add_u32 s59, s59, 393216
    v_add_u32 v82, s59, v82
    v_add_u32 v83, s59, v83
    s_add_u32 s70, s44, 331776
    s_addc_u32 s71, s45, 0
    s_add_u32 s72, s44, 340992
    s_addc_u32 s73, s45, 0
    s_add_u32 s74, s44, 350208
    s_addc_u32 s75, s45, 0
    s_add_u32 s76, s44, 359424
    s_addc_u32 s77, s45, 0
    v_lshlrev_b32 v80, 7, v81
    v_add_u32 v80, 129024, v80
    v_and_b32 v7, 12, v2
    v_add3_u32 v4, v80, v7, s69
    v_lshrrev_b32 v7, 1, v2
    v_add3_u32 v7, v80, v7, s69
    v_lshlrev_b32 v81, 4, v81
    s_mov_b32 s69, 0x3ae38e39
    v_mov_b32 v54, 146724
L_mrw:
    ds_read_b32 v55, v54
    s_waitcnt lgkmcnt(0)
    v_cmp_gt_u32 vcc, 14, v55
    s_cbranch_vccz L_mrw_ok
    s_sleep 2
    s_sub_u32 s13, s13, 1
    s_cbranch_scc0 L_mrw
    s_branch L_end
L_mrw_ok:
L_poll_mr:
    s_mov_b64 exec, -1
    s_add_u32 m0, s58, 0
    v_add_u32 v54, 0, v52
    global_load_lds_dwordx4 v54, s[44:45] sc1
    s_add_u32 m0, s58, 1536
    v_add_u32 v54, 4608, v52
    global_load_lds_dwordx4 v54, s[44:45] sc1
    s_add_u32 m0, s58, 3072
    v_add_u32 v54, 9216, v52
    global_load_lds_dwordx4 v54, s[44:45] sc1
    s_mov_b32 exec_hi, 0
    s_add_u32 m0, s58, 1024
    v_add_u32 v54, 0, v53
    global_load_lds_dwordx4 v54, s[44:45] sc1
    s_add_u32 m0, s58, 2560
    v_add_u32 v54, 4608, v53
    global_load_lds_dwordx4 v54, s[44:45] sc1
    s_add_u32 m0, s58, 4096
    v_add_u32 v54, 9216, v53
    global_load_lds_dwordx4 v54, s[44:45] sc1
    s_mov_b64 exec, -1
    s_waitcnt vmcnt(0)
    ds_read_b128 v[16:19], v15 offset:0
    ds_read_b128 v[20:23], v15 offset:16
    ds_read_b128 v[24:27], v87 offset:1024
    ds_read_b128 v[28:31], v15 offset:1536
    ds_read_b128 v[32:35], v15 offset:1552
    ds_read_b128 v[36:39], v87 offset:2560
    ds_read_b128 v[40:43], v15 offset:3072
    ds_read_b128 v[44:47], v15 offset:3088
    ds_read_b128 v[48:51], v87 offset:4096
    s_waitcnt lgkmcnt(0)
L_mr_chk:
    v_xor_b32 v54, s10, v17
    v_xor_b32 v55, s10, v19
    v_or_b32 v54, v54, v55
    v_xor_b32 v55, s10, v21
    v_or_b32 v54, v54, v55
    v_xor_b32 v55, s10, v23
    v_or_b32 v54, v54, v55
    v_xor_b32 v55, s10, v25
    v_or_b32 v54, v54, v55
    v_xor_b32 v55, s10, v27
    v_or_b32 v54, v54, v55
    v_xor_b32 v55, s10, v29
    v_or_b32 v54, v54, v55
    v_xor_b32 v55, s10, v31
    v_or_b32 v54, v54, v55
    v_xor_b32 v55, s10, v33
    v_or_b32 v54, v54, v55
    v_xor_b32 v55, s10, v35
    v_or_b32 v54, v54, v55
    v_xor_b32 v55, s10, v37
    v_or_b32 v54, v54, v55
    v_xor_b32 v55, s10, v39
    v_or_b32 v54, v54, v55
    v_xor_b32 v55, s10, v41
    v_or_b32 v54, v54, v55
    v_xor_b32 v55, s10, v43
    v_or_b32 v54, v54, v55
    v_xor_b32 v55, s10, v45
    v_or_b32 v54, v54, v55
    v_xor_b32 v55, s10, v47
    v_or_b32 v54, v54, v55
    v_xor_b32 v55, s10, v49
    v_or_b32 v54, v54, v55
    v_xor_b32 v55, s10, v51
    v_or_b32 v54, v54, v55
    v_cmp_ne_u32 vcc, 0, v54
    s_cbranch_vccz L_poll_mr_ok
    s_mov_b64 exec, vcc
    s_sub_u32 s13, s13, 1
    s_cbranch_scc0 L_poll_mr
    s_branch L_end
L_poll_mr_ok:
    s_mov_b64 exec, -1
    v_lshrrev_b32 v88, v81, v16
    v_lshlrev_b32 v88, 16, v88
    v_lshrrev_b32 v89, v81, v18
    v_lshlrev_b32 v89, 16, v89
    v_lshrrev_b32 v90, v81, v20
    v_lshlrev_b32 v90, 16, v90
    v_lshrrev_b32 v91, v81, v22
    v_lshlrev_b32 v91, 16, v91
    v_lshrrev_b32 v92, v81, v24
    v_lshlrev_b32 v92, 16, v92
    v_lshrrev_b32 v93, v81, v26
    v_lshlrev_b32 v93, 16, v93
    v_lshrrev_b32 v94, v81, v28
    v_lshlrev_b32 v94, 16, v94
    v_lshrrev_b32 v95, v81, v30
    v_lshlrev_b32 v95, 16, v95
    v_lshrrev_b32 v96, v81, v32
    v_lshlrev_b32 v96, 16, v96
    v_lshrrev_b32 v97, v81, v34
    v_lshlrev_b32 v97, 16, v97
    v_lshrrev_b32 v98, v81, v36
    v_lshlrev_b32 v98, 16, v98
    v_lshrrev_b32 v99, v81, v38
    v_lshlrev_b32 v99, 16, v99
    v_lshrrev_b32 v100, v81, v40
    v_lshlrev_b32 v100, 16, v100
    v_lshrrev_b32 v101, v81, v42
    v_lshlrev_b32 v101, 16, v101
    v_lshrrev_b32 v102, v81, v44
    v_lshlrev_b32 v102, 16, v102
    v_lshrrev_b32 v103, v81, v46
    v_lshlrev_b32 v103, 16, v103
    v_lshrrev_b32 v104, v81, v48
    v_lshlrev_b32 v104, 16, v104
    v_lshrrev_b32 v105, v81, v50
    v_lshlrev_b32 v105, 16, v105
    v_add_f32 v100, 1.0, v100
    v_add_f32 v101, 1.0, v101
    v_cvt_pk_bf16_f32 v52, v100, v101
    v_lshlrev_b32 v100, 16, v52
    v_and_b32 v101, s54, v52
    v_add_f32 v102, 1.0, v102
    v_add_f32 v103, 1.0, v103
    v_cvt_pk_bf16_f32 v52, v102, v103
    v_lshlrev_b32 v102, 16, v52
    v_and_b32 v103, s54, v52
    v_add_f32 v104, 1.0, v104
    v_add_f32 v105, 1.0, v105
    v_cvt_pk_bf16_f32 v52, v104, v105
    v_lshlrev_b32 v104, 16, v52
    v_and_b32 v105, s54, v52
    v_lshlrev_b32 v106, 16, v84
    v_and_b32 v107, s54, v84
    v_lshlrev_b32 v108, 16, v85
    v_and_b32 v109, s54, v85
    v_lshlrev_b32 v110, 16, v86
    v_and_b32 v111, s54, v86
    v_pk_add_f32 v[40:41], v[100:101], v[102:103]
    v_pk_mul_f32 v[42:43], v[100:101], v[100:101]
    v_pk_mul_f32 v[44:45], v[100:101], v[94:95]
    v_pk_add_f32 v[46:47], v[94:95], v[96:97]
    v_pk_mul_f32 v[48:49], v[94:95], v[94:95]
    v_pk_add_f32 v[40:41], v[40:41], v[104:105]
    v_pk_fma_f32 v[42:43], v[102:103], v[102:103], v[42:43]
    v_pk_fma_f32 v[44:45], v[102:103], v[96:97], v[44:45]
    v_pk_add_f32 v[46:47], v[46:47], v[98:99]
    v_pk_fma_f32 v[48:49], v[96:97], v[96:97], v[48:49]
    v_pk_fma_f32 v[42:43], v[104:105], v[104:105], v[42:43]
    v_pk_fma_f32 v[44:45], v[104:105], v[98:99], v[44:45]
    v_pk_fma_f32 v[48:49], v[98:99], v[98:99], v[48:49]
    v_add_f32 v112, v40, v41
    v_add_f32 v113, v42, v43
    v_add_f32 v114, v44, v45
    v_add_f32 v115, v46, v47
    v_add_f32 v116, v48, v49
    v_mov_b32 v117, 0
    v_add_f32_dpp v112, v112, v112 row_ror:8 row_mask:0xf bank_mask:0x3
    v_add_f32_dpp v113, v113, v113 row_ror:8 row_mask:0xf bank_mask:0x3
    v_add_f32_dpp v116, v116, v116 row_ror:8 row_mask:0xf bank_mask:0x3
    v_add_f32_dpp v112, v114, v114 row_ror:8 row_mask:0xf bank_mask:0xc
    v_add_f32_dpp v113, v115, v115 row_ror:8 row_mask:0xf bank_mask:0xc
    v_add_f32_dpp v116, v117, v117 row_ror:8 row_mask:0xf bank_mask:0xc
    v_add_f32_dpp v112, v112, v112 row_half_mirror row_mask:0xf bank_mask:0x5
    s_nop 0
    v_add_f32_dpp v116, v116, v116 row_half_mirror row_mask:0xf bank_mask:0xf
    v_add_f32_dpp v112, v113, v113 row_half_mirror row_mask:0xf bank_mask:0xa
    s_nop 0
    v_add_f32_dpp v116, v116, v116 quad_perm:[1,0,3,2] row_mask:0xf bank_mask:0xf
    v_add_f32_dpp v112, v112, v112 quad_perm:[1,0,3,2] row_mask:0xf bank_mask:0xf
    s_nop 0
    v_add_f32_dpp v116, v116, v116 quad_perm:[2,3,0,1] row_mask:0xf bank_mask:0xf
    v_add_f32_dpp v112, v112, v112 quad_perm:[2,3,0,1] row_mask:0xf bank_mask:0xf
    v_mov_b32 v117, v116
    v_mov_b32 v113, v112
    s_nop 0
    v_permlane16_swap_b32 v116, v117
    v_permlane16_swap_b32 v112, v113
    v_add_f32 v116, v116, v117
    v_add_f32 v112, v112, v113
    s_mov_b32 exec_lo, 0x0101
    s_mov_b32 exec_hi, 0x0101
    ds_write_b32 v7, v116 offset:16
    s_mov_b32 exec_lo, 0x1111
    s_mov_b32 exec_hi, 0x1111
    ds_write_b32 v4, v112 offset:0
    s_mov_b64 exec, -1
    v_mov_b32 v10, 146752
    v_mov_b32 v11, 1
    s_mov_b64 exec, 1
    ds_add_u32 v10, v11
    s_mov_b64 exec, -1
    v_mov_b32 v10, 146752
L_cs0:
    ds_read_b32 v12, v10
    s_waitcnt lgkmcnt(0)
    v_cmp_gt_u32 vcc, 3, v12
    s_cbranch_vccz L_cs0_ok
    s_sleep 1
    s_sub_u32 s13, s13, 1
    s_cbranch_scc0 L_cs0
    s_branch L_end
L_cs0_ok:
    ds_read_b128 v[112:115], v80 offset:0
    ds_read_b128 v[64:67], v80 offset:32
    ds_read_b128 v[68:71], v80 offset:64
    ds_read_b64 v[116:117], v80 offset:16
    ds_read_b64 v[72:73], v80 offset:48
    ds_read_b64 v[74:75], v80 offset:80
    s_waitcnt lgkmcnt(3)
    v_pk_add_f32 v[112:113], v[112:113], v[64:65]
    v_pk_add_f32 v[112:113], v[112:113], v[68:69]
    v_pk_add_f32 v[114:115], v[114:115], v[66:67]
    v_pk_add_f32 v[114:115], v[114:115], v[70:71]
    s_waitcnt lgkmcnt(0)
    v_pk_add_f32 v[116:117], v[116:117], v[72:73]
    v_pk_add_f32 v[116:117], v[116:117], v[74:75]
    s_mul_i32 s59, s4, 9216
    s_add_u32 s59, s59, 425984
    v_lshl_add_u32 v13, v118, 1, s59
    v_lshl_add_u32 v14, v119, 1, s59
    v_mov_b32 v8, 146740
L_pw2:
    ds_read_b32 v12, v8
    s_waitcnt lgkmcnt(0)
    v_cmp_gt_u32 vcc, 2, v12
    s_cbranch_vccz L_pw2_ok
    s_sleep 1
    s_sub_u32 s13, s13, 1
    s_cbranch_scc0 L_pw2
    s_branch L_end
L_pw2_ok:
    s_sub_u32 s58, s3, 2
    s_lshl_b32 s59, s58, 8
    s_mul_i32 s58, s58, 12288
    v_lshl_add_u32 v126, v1, 4, s58
    v_lshl_add_u32 v127, v1, 3, s58
    v_mul_u32_u24 v9, 2304, v3
    v_lshl_add_u32 v9, v2, 4, v9
    v_add_u32 v9, s59, v9
    s_add_u32 s70, s44, 327680
    s_addc_u32 s71, s45, 0
    s_add_u32 s72, s44, 332288
    s_addc_u32 s73, s45, 0
    s_add_u32 s74, s44, 336896
    s_addc_u32 s75, s45, 0
    s_add_u32 s76, s44, 341504
    s_addc_u32 s77, s45, 0
    s_add_u32 s18, s44, 346112
    s_addc_u32 s19, s45, 0
    s_add_u32 s20, s44, 350720
    s_addc_u32 s21, s45, 0
    s_add_u32 s22, s44, 355328
    s_addc_u32 s23, s45, 0
    s_add_u32 s24, s44, 359936
    s_addc_u32 s25, s45, 0
    v_add_u32 v9, 1536, v9
    v_mov_b32 v16, -1
    v_mov_b32 v17, -1
    v_mov_b32 v18, -1
    v_mov_b32 v19, -1
    ds_write_b128 v126, v[16:19] offset:0
    ds_write_b128 v126, v[16:19] offset:1024
    ds_write_b128 v126, v[16:19] offset:2048
    ds_write_b128 v126, v[16:19] offset:3072
    ds_write_b128 v126, v[16:19] offset:4096
    ds_write_b128 v126, v[16:19] offset:5120
    ds_write_b128 v126, v[16:19] offset:6144
    ds_write_b128 v126, v[16:19] offset:7168
    ds_write_b128 v126, v[16:19] offset:8192
    ds_write_b128 v126, v[16:19] offset:9216
    ds_write_b128 v126, v[16:19] offset:10240
    ds_write_b128 v126, v[16:19] offset:11264
    s_waitcnt lgkmcnt(0)
    s_movk_i32 s68, 0xff
L_h4_chk:
    s_waitcnt vmcnt(40)
    s_and_b32 s59, s68, 15
    s_cbranch_scc0 L_h4_n3
    s_bitcmp0_b32 s68, 0
    s_cbranch_scc1 L_h4_n0
    ds_read_b128 v[16:19], v126 offset:0
    ds_read_b64 v[48:49], v127 offset:1024
    s_add_u32 m0, s58, 0
    s_nop 0
    global_load_lds_dwordx4 v118, s[70:71] sc1
    s_add_u32 m0, s58, 1024
    s_mov_b32 exec_hi, 0
    global_load_lds_dwordx4 v9, s[70:71] sc1
    s_mov_b32 exec_hi, -1
    s_waitcnt lgkmcnt(0)
    v_max3_u32 v76, v16, v17, v18
    v_max3_u32 v76, v76, v19, v48
    v_max_u32 v76, v76, v49
    v_cmp_eq_u32 vcc, -1, v76
    s_cbranch_vccnz L_h4_n0
    s_bitset0_b32 s68, 0
L_h4_n0:
    s_bitcmp0_b32 s68, 1
    s_cbranch_scc1 L_h4_n1
    ds_read_b128 v[20:23], v126 offset:1536
    ds_read_b64 v[50:51], v127 offset:2560
    s_add_u32 m0, s58, 1536
    s_nop 0
    global_load_lds_dwordx4 v118, s[72:73] sc1
    s_add_u32 m0, s58, 2560
    s_mov_b32 exec_hi, 0
    global_load_lds_dwordx4 v9, s[72:73] sc1
    s_mov_b32 exec_hi, -1
    s_waitcnt lgkmcnt(0)
    v_max3_u32 v76, v20, v21, v22
    v_max3_u32 v76, v76, v23, v50
    v_max_u32 v76, v76, v51
    v_cmp_eq_u32 vcc, -1, v76
    s_cbranch_vccnz L_h4_n1
    s_bitset0_b32 s68, 1
L_h4_n1:
    s_bitcmp0_b32 s68, 2
    s_cbranch_scc1 L_h4_n2
    ds_read_b128 v[24:27], v126 offset:3072
    ds_read_b64 v[52:53], v127 offset:4096
    s_add_u32 m0, s58, 3072
    s_nop 0
    global_load_lds_dwordx4 v118, s[74:75] sc1
    s_add_u32 m0, s58, 4096
    s_mov_b32 exec_hi, 0
    global_load_lds_dwordx4 v9, s[74:75] sc1
    s_mov_b32 exec_hi, -1
    s_waitcnt lgkmcnt(0)
    v_max3_u32 v76, v24, v25, v26
    v_max3_u32 v76, v76, v27, v52
    v_max_u32 v76, v76, v53
    v_cmp_eq_u32 vcc, -1, v76
    s_cbranch_vccnz L_h4_n2
    s_bitset0_b32 s68, 2
L_h4_n2:
    s_bitcmp0_b32 s68, 3
    s_cbranch_scc1 L_h4_m3
    ds_read_b128 v[28:31], v126 offset:4608
    ds_read_b64 v[54:55], v127 offset:5632
    s_add_u32 m0, s58, 4608
    s_nop 0
    global_load_lds_dwordx4 v118, s[76:77] sc1
    s_add_u32 m0, s58, 5632
    s_mov_b32 exec_hi, 0
    global_load_lds_dwordx4 v9, s[76:77] sc1
    s_mov_b32 exec_hi, -1
    s_waitcnt lgkmcnt(0)
    v_max3_u32 v76, v28, v29, v30
    v_max3_u32 v76, v76, v31, v54
    v_max_u32 v76, v76, v55
    v_cmp_eq_u32 vcc, -1, v76
    s_cbranch_vccnz L_h4_n3
    s_bitset0_b32 s68, 3
L_h4_m3:
    s_and_b32 s59, s68, 15
    s_cbranch_scc1 L_h4_n3
    v_pk_add_f32 v[64:65], v[16:17], v[20:21]
    v_pk_add_f32 v[66:67], v[18:19], v[22:23]
    v_pk_add_f32 v[68:69], v[48:49], v[50:51]
    v_pk_add_f32 v[64:65], v[64:65], v[24:25]
    v_pk_add_f32 v[66:67], v[66:67], v[26:27]
    v_pk_add_f32 v[68:69], v[68:69], v[52:53]
    v_pk_add_f32 v[64:65], v[64:65], v[28:29]
    v_pk_add_f32 v[66:67], v[66:67], v[30:31]
    v_pk_add_f32 v[68:69], v[68:69], v[54:55]
L_h4_n3:
    s_and_b32 s59, s68, 240
    s_cbranch_scc0 L_h4_n7
    s_bitcmp0_b32 s68, 4
    s_cbranch_scc1 L_h4_n4
    ds_read_b128 v[32:35], v126 offset:6144
    ds_read_b64 v[56:57], v127 offset:7168
    s_add_u32 m0, s58, 6144
    s_nop 0
    global_load_lds_dwordx4 v118, s[18:19] sc1
    s_add_u32 m0, s58, 7168
    s_mov_b32 exec_hi, 0
    global_load_lds_dwordx4 v9, s[18:19] sc1
    s_mov_b32 exec_hi, -1
    s_waitcnt lgkmcnt(0)
    v_max3_u32 v76, v32, v33, v34
    v_max3_u32 v76, v76, v35, v56
    v_max_u32 v76, v76, v57
    v_cmp_eq_u32 vcc, -1, v76
    s_cbranch_vccnz L_h4_n4
    s_bitset0_b32 s68, 4
L_h4_n4:
    s_bitcmp0_b32 s68, 5
    s_cbranch_scc1 L_h4_n5
    ds_read_b128 v[36:39], v126 offset:7680
    ds_read_b64 v[58:59], v127 offset:8704
    s_add_u32 m0, s58, 7680
    s_nop 0
    global_load_lds_dwordx4 v118, s[20:21] sc1
    s_add_u32 m0, s58, 8704
    s_mov_b32 exec_hi, 0
    global_load_lds_dwordx4 v9, s[20:21] sc1
    s_mov_b32 exec_hi, -1
    s_waitcnt lgkmcnt(0)
    v_max3_u32 v76, v36, v37, v38
    v_max3_u32 v76, v76, v39, v58
    v_max_u32 v76, v76, v59
    v_cmp_eq_u32 vcc, -1, v76
    s_cbranch_vccnz L_h4_n5
    s_bitset0_b32 s68, 5
L_h4_n5:
    s_bitcmp0_b32 s68, 6
    s_cbranch_scc1 L_h4_n6
    ds_read_b128 v[40:43], v126 offset:9216
    ds_read_b64 v[60:61], v127 offset:10240
    s_add_u32 m0, s58, 9216
    s_nop 0
    global_load_lds_dwordx4 v118, s[22:23] sc1
    s_add_u32 m0, s58, 10240
    s_mov_b32 exec_hi, 0
    global_load_lds_dwordx4 v9, s[22:23] sc1
    s_mov_b32 exec_hi, -1
    s_waitcnt lgkmcnt(0)
    v_max3_u32 v76, v40, v41, v42
    v_max3_u32 v76, v76, v43, v60
    v_max_u32 v76, v76, v61
    v_cmp_eq_u32 vcc, -1, v76
    s_cbranch_vccnz L_h4_n6
    s_bitset0_b32 s68, 6
L_h4_n6:
    s_bitcmp0_b32 s68, 7
    s_cbranch_scc1 L_h4_m7
    ds_read_b128 v[44:47], v126 offset:10752
    ds_read_b64 v[62:63], v127 offset:11776
    s_add_u32 m0, s58, 10752
    s_nop 0
    global_load_lds_dwordx4 v118, s[24:25] sc1
    s_add_u32 m0, s58, 11776
    s_mov_b32 exec_hi, 0
    global_load_lds_dwordx4 v9, s[24:25] sc1
    s_mov_b32 exec_hi, -1
    s_waitcnt lgkmcnt(0)
    v_max3_u32 v76, v44, v45, v46
    v_max3_u32 v76, v76, v47, v62
    v_max_u32 v76, v76, v63
    v_cmp_eq_u32 vcc, -1, v76
    s_cbranch_vccnz L_h4_n7
    s_bitset0_b32 s68, 7
L_h4_m7:
    s_and_b32 s59, s68, 240
    s_cbranch_scc1 L_h4_n7
    v_pk_add_f32 v[70:71], v[32:33], v[36:37]
    v_pk_add_f32 v[72:73], v[34:35], v[38:39]
    v_pk_add_f32 v[74:75], v[56:57], v[58:59]
    v_pk_add_f32 v[70:71], v[70:71], v[40:41]
    v_pk_add_f32 v[72:73], v[72:73], v[42:43]
    v_pk_add_f32 v[74:75], v[74:75], v[60:61]
    v_pk_add_f32 v[70:71], v[70:71], v[44:45]
    v_pk_add_f32 v[72:73], v[72:73], v[46:47]
    v_pk_add_f32 v[74:75], v[74:75], v[62:63]
L_h4_n7:
    s_cmp_eq_u32 s68, 0
    s_cbranch_scc1 L_h4_ok
    s_sub_u32 s13, s13, 1
    s_cbranch_scc0 L_h4_chk
    s_branch L_end
L_h4_ok:
    v_pk_add_f32 v[64:65], v[64:65], v[70:71]
    v_pk_add_f32 v[66:67], v[66:67], v[72:73]
    v_pk_add_f32 v[68:69], v[68:69], v[74:75]
    v_pk_fma_f32 v[64:65], v[64:65], v[88:89], v[106:107]
    v_pk_fma_f32 v[66:67], v[66:67], v[90:91], v[108:109]
    v_pk_fma_f32 v[68:69], v[68:69], v[92:93], v[110:111]
    v_pk_mul_f32 v[70:71], v[64:65], v[100:101]
    v_pk_mul_f32 v[72:73], v[66:67], v[102:103]
    v_pk_mul_f32 v[74:75], v[68:69], v[104:105]
    v_pk_add_f32 v[40:41], v[64:65], v[66:67]
    v_pk_mul_f32 v[42:43], v[64:65], v[64:65]
    v_pk_add_f32 v[44:45], v[70:71], v[72:73]
    v_pk_mul_f32 v[46:47], v[70:71], v[70:71]
    v_pk_mul_f32 v[48:49], v[70:71], v[100:101]
    v_pk_mul_f32 v[50:51], v[70:71], v[94:95]
    v_pk_add_f32 v[40:41], v[40:41], v[68:69]
    v_pk_fma_f32 v[42:43], v[66:67], v[66:67], v[42:43]
    v_pk_add_f32 v[44:45], v[44:45], v[74:75]
    v_pk_fma_f32 v[46:47], v[72:73], v[72:73], v[46:47]
    v_pk_fma_f32 v[48:49], v[72:73], v[102:103], v[48:49]
    v_pk_fma_f32 v[50:51], v[72:73], v[96:97], v[50:51]
    v_pk_fma_f32 v[42:43], v[68:69], v[68:69], v[42:43]
    v_pk_fma_f32 v[46:47], v[74:75], v[74:75], v[46:47]
    v_pk_fma_f32 v[48:49], v[74:75], v[104:105], v[48:49]
    v_pk_fma_f32 v[50:51], v[74:75], v[98:99], v[50:51]
    v_add_f32 v120, v40, v41
    v_add_f32 v121, v42, v43
    v_add_f32 v122, v44, v45
    v_add_f32 v123, v46, v47
    v_add_f32 v124, v48, v49
    v_add_f32 v125, v50, v51
    v_add_f32_dpp v120, v120, v120 row_ror:8 row_mask:0xf bank_mask:0x3
    v_add_f32_dpp v121, v121, v121 row_ror:8 row_mask:0xf bank_mask:0x3
    v_add_f32_dpp v124, v124, v124 row_ror:8 row_mask:0xf bank_mask:0x3
    v_add_f32_dpp v120, v122, v122 row_ror:8 row_mask:0xf bank_mask:0xc
    v_add_f32_dpp v121, v123, v123 row_ror:8 row_mask:0xf bank_mask:0xc
    v_add_f32_dpp v124, v125, v125 row_ror:8 row_mask:0xf bank_mask:0xc
    v_add_f32_dpp v120, v120, v120 row_half_mirror row_mask:0xf bank_mask:0x5
    s_nop 0
    v_add_f32_dpp v124, v124, v124 row_half_mirror row_mask:0xf bank_mask:0xf
    v_add_f32_dpp v120, v121, v121 row_half_mirror row_mask:0xf bank_mask:0xa
    s_nop 0
    v_add_f32_dpp v124, v124, v124 quad_perm:[1,0,3,2] row_mask:0xf bank_mask:0xf
    v_add_f32_dpp v120, v120, v120 quad_perm:[1,0,3,2] row_mask:0xf bank_mask:0xf
    s_nop 0
    v_add_f32_dpp v124, v124, v124 quad_perm:[2,3,0,1] row_mask:0xf bank_mask:0xf
    v_add_f32_dpp v120, v120, v120 quad_perm:[2,3,0,1] row_mask:0xf bank_mask:0xf
    v_mov_b32 v125, v124
    v_mov_b32 v121, v120
    s_nop 0
    v_permlane16_swap_b32 v124, v125
    v_permlane16_swap_b32 v120, v121
    v_add_f32 v124, v124, v125
    v_add_f32 v120, v120, v121
    s_mov_b32 exec_lo, 0x0101
    s_mov_b32 exec_hi, 0x0101
    ds_write_b32 v7, v124 offset:272
    s_mov_b32 exec_lo, 0x1111
    s_mov_b32 exec_hi, 0x1111
    ds_write_b32 v4, v120 offset:256
    s_mov_b64 exec, 1
    ds_add_u32 v10, v11
    s_mov_b64 exec, -1
L_cs1:
    ds_read_b32 v12, v10
    ds_read_b128 v[120:123], v80 offset:256
    ds_read_b128 v[40:43], v80 offset:288
    ds_read_b128 v[44:47], v80 offset:320
    ds_read_b64 v[124:125], v80 offset:272
    ds_read_b64 v[48:49], v80 offset:304
    ds_read_b64 v[50:51], v80 offset:336
    s_waitcnt lgkmcnt(3)
    v_pk_add_f32 v[120:121], v[120:121], v[40:41]
    v_pk_add_f32 v[120:121], v[120:121], v[44:45]
    v_pk_add_f32 v[122:123], v[122:123], v[42:43]
    v_pk_add_f32 v[122:123], v[122:123], v[46:47]
    s_waitcnt lgkmcnt(0)
    v_pk_add_f32 v[124:125], v[124:125], v[48:49]
    v_pk_add_f32 v[124:125], v[124:125], v[50:51]
    v_cmp_ne_u32 vcc, 6, v12
    s_cbranch_vccz L_cs1_ok
    s_sub_u32 s13, s13, 1
    s_cbranch_scc0 L_cs1
    s_branch L_end
L_cs1_ok:
    v_mul_f32 v120, s69, v120
    v_mul_f32 v121, s69, v121
    v_fma_f32 v121, -v120, v120, v121
    v_max_f32 v121, 0, v121
    v_add_f32 v121, 0x3727c5ac, v121
    v_rsq_f32 v121, v121
    v_fma_f32 v78, -v120, v113, v124
    v_fma_f32 v125, -v120, v114, v125
    v_add_f32 v78, v78, v124
    v_fma_f32 v122, -v120, v112, v122
    v_fma_f32 v123, -v120, v78, v123
    v_add_f32 v125, v125, v125
    v_fma_f32 v123, v123, v121, v125
    v_fma_f32 v122, v122, v121, v115
    v_fma_f32 v123, v123, v121, v116
    v_mul_f32 v122, s69, v122
    v_mul_f32 v123, s69, v123
    v_fma_f32 v123, -v122, v122, v123
    v_max_f32 v123, 0, v123
    v_add_f32 v123, 0x3727c5ac, v123
    v_rsq_f32 v123, v123
    v_pk_fma_f32 v[70:71], v[100:101], v[120:121], v[70:71] op_sel_hi:[1,0,1] neg_lo:[0,1,0] neg_hi:[0,1,0]
    v_pk_fma_f32 v[72:73], v[102:103], v[120:121], v[72:73] op_sel_hi:[1,0,1] neg_lo:[0,1,0] neg_hi:[0,1,0]
    v_pk_fma_f32 v[74:75], v[104:105], v[120:121], v[74:75] op_sel_hi:[1,0,1] neg_lo:[0,1,0] neg_hi:[0,1,0]
    v_pk_add_f32 v[94:95], v[94:95], v[122:123] op_sel_hi:[1,0] neg_lo:[0,1] neg_hi:[0,1]
    v_pk_add_f32 v[96:97], v[96:97], v[122:123] op_sel_hi:[1,0] neg_lo:[0,1] neg_hi:[0,1]
    v_pk_add_f32 v[98:99], v[98:99], v[122:123] op_sel_hi:[1,0] neg_lo:[0,1] neg_hi:[0,1]
    v_pk_fma_f32 v[70:71], v[70:71], v[120:121], v[94:95] op_sel:[0,1,0] op_sel_hi:[1,1,1]
    v_pk_fma_f32 v[72:73], v[72:73], v[120:121], v[96:97] op_sel:[0,1,0] op_sel_hi:[1,1,1]
    v_pk_fma_f32 v[74:75], v[74:75], v[120:121], v[98:99] op_sel:[0,1,0] op_sel_hi:[1,1,1]
    v_pk_mul_f32 v[70:71], v[70:71], v[122:123] op_sel:[0,1] op_sel_hi:[1,1]
    v_pk_mul_f32 v[72:73], v[72:73], v[122:123] op_sel:[0,1] op_sel_hi:[1,1]
    v_pk_mul_f32 v[74:75], v[74:75], v[122:123] op_sel:[0,1] op_sel_hi:[1,1]
    v_cvt_pk_bf16_f32 v70, v70, v71
    v_cvt_pk_bf16_f32 v71, v72, v73
    v_cvt_pk_bf16_f32 v72, v74, v75
    v_min_u32 v70, -2, v70
    v_min_u32 v71, -2, v71
    v_min_u32 v72, -2, v72
    global_store_dwordx2 v82, v[70:71], s[64:65]
    global_store_dword v83, v72, s[64:65] offset:768
    global_store_dwordx2 v82, v[70:71], s[44:45] sc1
    global_store_dword v83, v72, s[44:45] offset:768 sc1
    v_mov_b32 v16, v64
    v_mov_b32 v17, s10
    v_mov_b32 v18, v65
    v_mov_b32 v19, s10
    v_mov_b32 v20, v66
    v_mov_b32 v21, s10
    v_mov_b32 v22, v67
    v_mov_b32 v23, s10
    v_mov_b32 v24, v68
    v_mov_b32 v25, s10
    v_mov_b32 v26, v69
    v_mov_b32 v27, s10
    global_store_dwordx4 v13, v[16:19], s[44:45] sc1
    global_store_dwordx4 v13, v[20:23], s[44:45] offset:16 sc1
    global_store_dwordx4 v14, v[24:27], s[44:45] offset:3072 sc1
    s_cmp_lg_u32 s4, 0
    s_cbranch_scc1 L_end
    s_cmp_lg_u32 s3, 2
    s_cbranch_scc1 L_end
    s_mov_b64 exec, 1
    v_mov_b32 v4, 0
    global_store_dword v4, v17, s[44:45] sc1
    s_branch L_end
L_mlp_gelu:
    v_and_b32 v6, 31, v1
    s_lshl_b32 s14, s12, 6
    v_lshl_add_u32 v6, v6, 1, s14
    v_lshlrev_b32 v4, 2, v1
    v_add_u32 v4, 152832, v4
    v_lshlrev_b32 v5, 1, v1
    v_add_u32 v5, 157968, v5
    s_mov_b32 s56, 0x3d372713
    s_mov_b32 s57, 0xc0135761
    global_load_ushort v15, v6, s[30:31]
    s_waitcnt vmcnt(0)
    v_lshlrev_b32 v15, 16, v15
    s_barrier
    ds_read2st64_b32 v[24:25], v4 offset0:0 offset1:1
    ds_read2st64_b32 v[26:27], v4 offset0:2 offset1:3
    ds_read2st64_b32 v[28:29], v4 offset0:4 offset1:5
    ds_read2st64_b32 v[30:31], v4 offset0:6 offset1:7
    ds_read_b32 v32, v4 offset:2048
    s_waitcnt lgkmcnt(0)
    v_pk_add_f32 v[24:25], v[24:25], v[26:27]
    v_pk_add_f32 v[28:29], v[28:29], v[30:31]
    v_add_f32 v32, v32, v15
    v_pk_add_f32 v[24:25], v[24:25], v[28:29]
    v_add_f32 v24, v24, v32
    v_add_f32 v24, v24, v25
    v_mul_f32 v25, v24, v24
    v_mul_f32 v26, s57, v24
    v_fma_f32 v25, v25, s56, 1.0
    v_mul_f32 v25, v25, v26
    v_exp_f32 v25, v25
    s_nop 0
    v_add_f32 v25, 1.0, v25
    v_rcp_f32 v25, v25
    s_nop 0
    v_mul_f32 v24, v24, v25
    v_cvt_pk_bf16_f32 v24, v24, v24
    ds_write_b16 v5, v24
    s_waitcnt lgkmcnt(0)
    s_barrier
    s_branch L_end
L_mlp_fin:
    s_waitcnt lgkmcnt(0)
    s_mul_i32 s10, s55, 1664525
    s_add_u32 s10, s10, 1013904223
    s_max_u32 s10, s10, 1
    s_cmp_ge_u32 s12, 72
    s_cselect_b32 s56, 72, 0
    s_cselect_b32 s58, 16, 0
    s_sub_u32 s56, s12, s56
    v_and_b32 v4, 1, v1
    v_and_b32 v5, 1, v3
    v_lshrrev_b32 v6, 1, v3
    v_lshl_add_u32 v5, v5, 1, v6
    v_lshl_add_u32 v14, v4, 2, v5
    s_lshl_b32 s57, s56, 4
    v_lshl_add_u32 v6, v14, 1, s57
    v_lshlrev_b32 v5, 2, v6
    v_add_u32 v5, 27136, v5
    global_load_ushort v40, v6, s[34:35]
    v_mov_b32 v20, 146740
L_fw:
    ds_read_b32 v21, v20
    s_waitcnt lgkmcnt(0)
    v_cmp_gt_u32 vcc, 2, v21
    s_cbranch_vccz L_fw_ok
    s_sleep 4
    s_sub_u32 s13, s13, 1
    s_cbranch_scc0 L_fw
    s_branch L_end
L_fw_ok:
L_poll_gb:
    global_load_dwordx2 v[16:17], v5, s[44:45] sc1
    s_waitcnt vmcnt(0)
    v_cmp_ne_u32 vcc, s10, v17
    s_cbranch_vccz L_poll_gb_ok
    s_mov_b64 exec, vcc
    s_sub_u32 s13, s13, 1
    s_cbranch_scc0 L_poll_gb
    s_branch L_end
L_poll_gb_ok:
    s_mov_b64 exec, -1
    v_lshrrev_b32 v36, s58, v16
    v_lshlrev_b32 v36, 16, v36
    v_lshlrev_b32 v40, 16, v40
    s_lshl_b32 s57, s12, 5
    v_lshl_add_u32 v7, v14, 2, s57
    v_lshrrev_b32 v13, 1, v7
    s_mul_i32 s59, s4, 9216
    s_add_u32 s59, s59, 425984
    v_lshl_add_u32 v7, v7, 1, s59
    v_lshl_add_u32 v6, v4, 4, s57
    v_lshrrev_b32 v8, 1, v1
    v_mul_u32_u24 v8, 4736, v8
    v_add_u32 v8, 1048576, v8
    v_add_u32 v8, v8, v6
    v_add_u32 v9, 151552, v8
    v_add_u32 v10, 151552, v9
    v_add_u32 v11, 151552, v10
    v_add_u32 v12, 151552, v11
    v_cmp_gt_u32 vcc, 32, v1
    s_nop 1
    v_cndmask_b32 v12, v11, v12, vcc
    s_mov_b64 s[50:51], vcc
    s_barrier
    s_barrier
    s_barrier
L_poll_h5:
    global_load_dwordx2 v[44:45], v7, s[44:45] sc1
    global_load_dwordx4 v[16:19], v8, s[44:45] sc1
    global_load_dwordx4 v[20:23], v9, s[44:45] sc1
    global_load_dwordx4 v[24:27], v10, s[44:45] sc1
    global_load_dwordx4 v[28:31], v11, s[44:45] sc1
    global_load_dwordx4 v[32:35], v12, s[44:45] sc1
    s_waitcnt vmcnt(0)
    v_max3_u32 v14, v16, v17, v18
    v_max3_u32 v14, v14, v19, v20
    v_max3_u32 v14, v14, v21, v22
    v_max3_u32 v14, v14, v23, v24
    v_max3_u32 v14, v14, v25, v26
    v_max3_u32 v14, v14, v27, v28
    v_max3_u32 v14, v14, v29, v30
    v_max3_u32 v14, v14, v31, v32
    v_max3_u32 v14, v14, v33, v34
    v_max_u32 v14, v14, v35
    v_cmp_ne_u32 s[60:61], s10, v45
    v_cmp_eq_u32 vcc, -1, v14
    s_nop 0
    s_or_b64 vcc, vcc, s[60:61]
    s_cbranch_vccz L_poll_h5_ok
    s_mov_b64 exec, vcc
    s_sub_u32 s13, s13, 1
    s_cbranch_scc0 L_poll_h5
    s_branch L_end
L_poll_h5_ok:
    s_mov_b64 exec, s[50:51]
    v_pk_add_f32 v[16:17], v[16:17], v[32:33]
    v_pk_add_f32 v[18:19], v[18:19], v[34:35]
    s_mov_b64 exec, -1
    v_pk_add_f32 v[24:25], v[24:25], v[28:29]
    v_pk_add_f32 v[26:27], v[26:27], v[30:31]
    v_pk_add_f32 v[16:17], v[16:17], v[20:21]
    v_pk_add_f32 v[18:19], v[18:19], v[22:23]
    v_pk_add_f32 v[16:17], v[16:17], v[24:25]
    v_pk_add_f32 v[18:19], v[18:19], v[26:27]
    s_nop 0
    v_permlane32_swap_b32 v16, v17
    v_permlane32_swap_b32 v18, v19
    v_add_f32 v16, v16, v17
    v_add_f32 v18, v18, v19
    s_nop 1
    v_permlane16_swap_b32 v16, v18
    v_add_f32 v16, v16, v18
    s_nop 1
    v_add_f32_dpp v16, v16, v16 row_ror:8 row_mask:0xf bank_mask:0xf
    s_nop 1
    v_add_f32_dpp v16, v16, v16 row_ror:4 row_mask:0xf bank_mask:0xf
    s_nop 1
    v_add_f32_dpp v16, v16, v16 row_ror:2 row_mask:0xf bank_mask:0xf
    s_mov_b32 exec_lo, 0x00030003
    s_mov_b32 exec_hi, 0x00030003
    v_add_f32 v16, v16, v40
    v_fmac_f32 v44, v16, v36
    v_cvt_pk_bf16_f32 v16, v44, v44
    global_store_short v13, v16, s[40:41]
L_fin2:
    s_branch L_end
L_end:
L_exit:
    s_endpgm
.section .rodata,"a"
.p2align 6
.amdhsa_kernel adaLN_cond__sliding_block_cached__mixer_channel_mlp__decode_kernel
  .amdhsa_next_free_vgpr 128
  .amdhsa_next_free_sgpr 102
  .amdhsa_accum_offset 128
  .amdhsa_group_segment_fixed_size 0
  .amdhsa_kernarg_size 120
  .amdhsa_user_sgpr_count 2
  .amdhsa_user_sgpr_kernarg_segment_ptr 1
  .amdhsa_system_sgpr_workgroup_id_x 1
.end_amdhsa_kernel
```
